```python
import torch

def _softmax(x, axis=-1):
    return torch.softmax(x, dim=axis)
def _gelu(x):
    return torch.nn.functional.gelu(x, approximate="tanh")
def _silu(x):
    return torch.nn.functional.silu(x)
def _sigmoid(x):
    return torch.sigmoid(x)
def _layernorm(x, axis=-1, eps=1e-5):
    m = x.mean(dim=axis, keepdim=True)
    v = x.var(dim=axis, keepdim=True, unbiased=False)
    return (x - m) / torch.sqrt(v + eps)
def _scatter_add(tgt, idx, src, axis=0):
    return tgt.clone().index_add_(axis, idx, src)
def _segment_sum(src, seg, n):
    out = torch.zeros((n,) + src.shape[1:], dtype=src.dtype)
    return out.index_add_(0, seg, src)
def _pad(x, pw):
    flat = tuple(v for pair in reversed(pw) for v in pair)
    return torch.nn.functional.pad(x, flat)

kernel_name = 'interleave_layers__compressed_kv_cla__glu_gated_geglu__decode'

def setup_inputs():

    _w = (lambda a: (lambda t: t.to(torch.bfloat16) if t.is_floating_point() else t)(torch.as_tensor(a)))
    def _A_setup():
        B, H, Sq, Sk, D, M = 2, 32, 1, 4096, 128, 512
        Dc = 4 * D
        return {
            "x": _w((lambda *s: torch.randn(*s, dtype=torch.bfloat16) * 0.05)(B, Sq, M)),
            "c_kv": _w((lambda *s: torch.randn(*s, dtype=torch.bfloat16) * 0.8)(B, Sk, Dc)),
            "w_q": _w((lambda *s: torch.randn(*s, dtype=torch.bfloat16) * 1.6)(M, H, D) * (M ** -0.5)),
            "w_uk": _w((lambda *s: torch.randn(*s, dtype=torch.bfloat16) * 1.6)(Dc, H, D) * (Dc ** -0.5)),
            "w_uv": _w((lambda *s: torch.randn(*s, dtype=torch.bfloat16) * 0.8)(Dc, H, D) * (Dc ** -0.5)),
            "w_o": _w((lambda *s: torch.randn(*s, dtype=torch.bfloat16) * 0.8)(H, D, M) * ((H * D) ** -0.5)),
        }
    _A_in = _A_setup()

    def _B_setup():
        B, S, Dm, Df = 2, 1, 512, 1376
        return {
            "x": _w((lambda *s: torch.randn(*s, dtype=torch.bfloat16) * 0.05)(B, S, Dm)),
            "w_gate": _w((lambda *s: torch.randn(*s, dtype=torch.bfloat16) * 0.4)(Dm, Df) * (Dm ** -0.5)),
            "w_up": _w((lambda *s: torch.randn(*s, dtype=torch.bfloat16) * 0.4)(Dm, Df) * (Dm ** -0.5)),
            "w_down": _w((lambda *s: torch.randn(*s, dtype=torch.bfloat16) * 0.4)(Df, Dm) * (Df ** -0.5)),
        }
    _B_in = _B_setup()

    return {
        "A_x": _A_in["x"],
        "A_c_kv": _A_in["c_kv"],
        "A_w_q": _A_in["w_q"],
        "A_w_uk": _A_in["w_uk"],
        "A_w_uv": _A_in["w_uv"],
        "A_w_o": _A_in["w_o"],
        "B_x": _B_in["x"],
        "B_w_gate": _B_in["w_gate"],
        "B_w_up": _B_in["w_up"],
        "B_w_down": _B_in["w_down"],
    }

def reference(A_x, A_c_kv, A_w_q, A_w_uk, A_w_uv, A_w_o, B_x, B_w_gate, B_w_up, B_w_down):
    def _A_ref(x, c_kv, w_q, w_uk, w_uv, w_o):
        B, Sq, M = x.shape[0], x.shape[1], x.shape[2]
        Sk = c_kv.shape[1]
        H, D = w_q.shape[1], w_q.shape[2]
        q = torch.einsum("bqm,mhd->bhqd", x, w_q)
        k = torch.einsum("bkc,chd->bhkd", c_kv, w_uk)
        v = torch.einsum("bkc,chd->bhkd", c_kv, w_uv)
        scores = torch.einsum("bhqd,bhkd->bhqk", q, k) * (D ** -0.5)
        off = Sk - Sq
        qi = torch.arange(Sq)[:, None]
        kj = torch.arange(Sk)[None, :]
        cmask = kj <= (qi + off)
        scores = torch.where(cmask[None, None], scores, -1e9)
        p = _softmax(scores, axis=-1)
        ctx = torch.einsum("bhqk,bhkd->bhqd", p, v)
        return torch.einsum("bhqd,hdm->bqm", ctx, w_o)

    def _B_ref(x, w_gate, w_up, w_down):
        g = torch.einsum("bsd,df->bsf", x, w_gate)
        u = torch.einsum("bsd,df->bsf", x, w_up)
        h = _gelu(g) * u
        return torch.einsum("bsf,fd->bsd", h, w_down)

    x = A_x
    x = x + _A_ref(_layernorm(x, axis=-1), A_c_kv, A_w_q, A_w_uk, A_w_uv, A_w_o)
    x = x + _B_ref(_layernorm(x, axis=-1), B_w_gate, B_w_up, B_w_down)
    x = x + _A_ref(_layernorm(x, axis=-1), A_c_kv, A_w_q, A_w_uk, A_w_uv, A_w_o)
    x = x + _B_ref(_layernorm(x, axis=-1), B_w_gate, B_w_up, B_w_down)
    return x
```

```asm
; @launch grid=(256,1,1) block=(256,1,1) lds=157952
.amdgcn_target "amdgcn-amd-amdhsa--gfx950"
.text
.p2align 12
.fill 832, 4, 0xbf810000
.globl interleave_layers__compressed_kv_cla__glu_gated_geglu__decode_kernel
.p2align 8
.type interleave_layers__compressed_kv_cla__glu_gated_geglu__decode_kernel,@function
interleave_layers__compressed_kv_cla__glu_gated_geglu__decode_kernel:
    s_cmp_ge_u32 s2, 256
    s_cbranch_scc1 Lend
    s_load_dwordx2 s[40:41], s[0:1], 16
    s_load_dwordx2 s[36:37], s[0:1], 0
    s_load_dwordx2 s[32:33], s[0:1], 96
    s_load_dwordx2 s[44:45], s[0:1], 24
    s_load_dwordx2 s[48:49], s[0:1], 8
    s_load_dwordx4 s[12:15], s[0:1], 32
    s_load_dwordx8 s[20:27], s[0:1], 56
    v_lshrrev_b32 v44, 6, v0
    v_and_b32 v1, 63, v0
    s_and_b32 s77, s2, 7
    v_readfirstlane_b32 s76, v44
    s_lshr_b32 s78, s2, 3
    v_and_b32 v225, 15, v0
    v_bfe_u32 v226, v0, 4, 2
    s_getpc_b64 s[86:87]
Lpc:
    s_lshl_b32 s85, s78, 9
    s_lshl_b32 s82, s76, 7
    s_add_u32 s85, s85, s82
    s_min_u32 s85, s85, Lend-interleave_layers__compressed_kv_cla__glu_gated_geglu__decode_kernel-128
    s_sub_u32 s85, s85, Lpc-interleave_layers__compressed_kv_cla__glu_gated_geglu__decode_kernel
    s_ashr_i32 s82, s85, 31
    s_add_u32 s86, s86, s85
    s_addc_u32 s87, s87, s82
    v_and_b32 v60, 31, v0
    v_lshlrev_b32 v60, 2, v60
    v_mov_b32 v61, s87
    v_add_co_u32 v60, vcc, s86, v60
    s_nop 1
    v_addc_co_u32 v61, vcc, 0, v61, vcc
    global_load_dword v251, v[60:61], off
    s_mov_b32 s34, 268435456
    s_mov_b32 s35, 0x20000
    s_mov_b32 s38, 2048
    s_mov_b32 s39, 0x20000
    s_mov_b32 s42, 4194304
    s_mov_b32 s43, 0x20000
    s_mov_b32 s46, 4194304
    s_mov_b32 s47, 0x20000
    s_lshr_b32 s79, s77, 2
    s_and_b32 s80, s77, 3
    s_lshr_b32 s100, s78, 3
    s_and_b32 s101, s78, 7
    s_mov_b32 s100, s100
    s_lshl_b32 s82, s80, 3
    s_add_u32 s100, s100, s82
    s_lshl_b32 s82, s79, 2
    s_add_u32 s100, s100, s82
    v_lshlrev_b32 v32, 3, v0
    v_lshlrev_b32 v52, 2, v226
    v_xor_b32 v52, v52, v225
    v_lshlrev_b32 v52, 4, v52
    v_lshl_add_u32 v38, v226, 13, v52
    v_xor_b32 v53, 16, v38
    v_xor_b32 v54, 32, v38
    v_xor_b32 v55, 48, v38
    s_lshl_b32 s81, s101, 19
    s_lshl_b32 s82, s100, 8
    s_add_u32 s81, s81, s82
    s_lshl_b32 s82, s76, 17
    s_add_u32 s81, s81, s82
    s_lshl_b32 s3, s76, 15
    s_add_u32 s3, s3, 28672
    s_mov_b32 s31, s81
    s_lshl_b32 s82, s76, 12
    s_add_u32 m0, s82, 133248
    s_lshl_b32 s30, s77, 16
    s_add_u32 s30, s30, 65536
    s_mul_i32 s82, s2, 640
    s_add_u32 s82, s82, 655360
    s_mul_i32 s83, s78, 1408
    s_add_u32 s83, s83, s30
    s_add_u32 s83, s83, 16384
    s_cmp_lt_u32 s76, 2
    s_cselect_b32 s83, s83, s82
    s_cselect_b32 s84, 88, 40
    v_and_b32 v47, 127, v0
    v_cmp_gt_u32 vcc, s84, v47
    v_lshl_add_u32 v47, v47, 4, s83
    v_mov_b32 v231, 1073741824
    v_mov_b32 v48, -1
    v_mov_b32 v49, -1
    v_mov_b32 v50, -1
    v_mov_b32 v51, -1
    v_cndmask_b32 v47, v231, v47, vcc
    s_lshr_b32 s83, s100, 3
    s_and_b32 s84, s100, 7
    s_lshl_b32 s89, s83, 14
    s_lshl_b32 s82, s101, 10
    s_add_u32 s89, s89, s82
    s_lshl_b32 s82, s84, 6
    s_add_u32 s89, s89, s82
    s_add_u32 s89, s89, 589824
    v_bfe_u32 v58, v0, 3, 1
    v_bfe_u32 v59, v0, 2, 1
    v_lshlrev_b32 v58, 13, v58
    v_lshl_add_u32 v58, v59, 9, v58
    v_and_b32 v227, 3, v0
    v_lshl_add_u32 v58, v227, 4, v58
    v_and_b32 v59, 0xf0, v0
    v_cmp_eq_u32 vcc, 0xc0, v59
    v_add_u32 v58, s89, v58
    v_lshl_add_u32 v208, v226, 10, v52
    v_cndmask_b32 v47, v47, v58, vcc
    v_xor_b32 v209, 16, v208
    v_add_u32 v209, 3072, v209
    v_xor_b32 v210, 32, v208
    v_add_u32 v210, 6144, v210
    v_xor_b32 v211, 48, v208
    v_add_u32 v211, 9216, v211
    s_mov_b32 s50, 8388608
    s_mov_b32 s51, 0x20000
    s_lshr_b32 s83, s78, 1
    s_xor_b32 s83, s83, s76
    s_and_b32 s83, s83, 1
    s_lshr_b32 s84, s76, 1
    s_lshr_b32 s88, s2, 5
    s_and_b32 s85, s2, 31
    s_lshl_b32 s16, s85, 8
    s_lshl_b32 s82, s84, 7
    s_add_u32 s16, s16, s82
    s_lshl_b32 s82, s83, 13
    s_add_u32 s16, s16, s82
    s_lshl_b32 s82, s88, 14
    s_add_u32 s16, s16, s82
    s_add_u32 s16, s16, 917504
    s_waitcnt lgkmcnt(0)
    s_load_dword s11, s[32:33], 0xdff80
    buffer_load_dword v79, off, s[32:35], 0 sc1
    buffer_load_dwordx2 v[56:57], v32, s[36:39], 0 offen
    buffer_load_dwordx4 v38, s[40:43], s81 offen offset:0 nt lds
    s_add_u32 s81, s81, 31744
    buffer_load_dwordx4 v38, s[40:43], s81 offen offset:1024 nt lds
    s_add_u32 s81, s81, 31744
    buffer_load_dwordx4 v38, s[40:43], s81 offen offset:2048 nt lds
    s_add_u32 s81, s81, 31744
    buffer_load_dwordx4 v38, s[40:43], s81 offen offset:3072 nt lds
    s_mov_b32 m0, s3
    s_nop 0
    buffer_load_dwordx4 v38, s[44:47], s31 offen offset:0 nt lds
    s_add_u32 s31, s31, 31744
    buffer_load_dwordx4 v53, s[44:47], s31 offen offset:1024 nt lds
    s_add_u32 s31, s31, 31744
    buffer_load_dwordx4 v54, s[44:47], s31 offen offset:2048 nt lds
    s_add_u32 s31, s31, 31744
    buffer_load_dwordx4 v55, s[44:47], s31 offen offset:3072 nt lds
    buffer_store_dwordx4 v[48:51], v47, s[32:35], 0 offen sc1
    s_mov_b64 s[52:53], s[12:13]
    s_mov_b64 s[56:57], s[14:15]
    s_mov_b64 s[60:61], s[20:21]
    s_mov_b64 s[64:65], s[22:23]
    s_mov_b64 s[68:69], s[24:25]
    s_mov_b64 s[72:73], s[26:27]
    s_and_b32 s31, s78, 3
    s_lshr_b32 s3, s78, 2
    s_lshl_b32 s81, s80, 3
    s_add_u32 s3, s3, s81
    s_lshl_b32 s21, s79, 22
    s_lshl_b32 s82, s3, 17
    s_add_u32 s21, s21, s82
    s_lshl_b32 s82, s76, 8
    s_add_u32 s21, s21, s82
    s_lshl_b32 s22, s76, 15
    s_lshl_b32 s25, s31, 15
Lwarm_0:
    s_mov_b64 exec, 0
    s_cmp_eq_u32 s76, 0
    s_cbranch_scc1 Lpad_0
    s_cmp_eq_u32 s76, 1
    s_cbranch_scc1 Lpad_1
    s_cmp_eq_u32 s76, 2
    s_cbranch_scc1 Lpad_2
    s_branch Lpad_3
Lresume_0:
    s_mov_b64 exec, -1
    s_mov_b32 s54, 4194304
    s_mov_b32 s55, 0x20000
    s_mov_b32 s58, 4194304
    s_mov_b32 s59, 0x20000
    s_mov_b32 s62, 1409024
    s_mov_b32 s63, 0x20000
    s_mov_b32 s66, 1409024
    s_mov_b32 s67, 0x20000
    s_mov_b32 s70, 1409024
    s_mov_b32 s71, 0x20000
    s_mov_b32 s74, 2048
    s_mov_b32 s75, 0x20000
    s_lshr_b32 s81, s76, 1
    s_and_b32 s7, s76, 1
    s_lshl_b32 s6, s81, 9
    s_lshl_b32 s82, s7, 3
    s_add_u32 s6, s6, s82
    s_add_u32 s6, s6, s89
    s_getreg_b32 s89, hwreg(HW_REG_XCC_ID, 0, 4)
    s_xor_b32 s81, s79, 1
    s_lshl_b32 s10, s81, 13
    s_lshl_b32 s82, s3, 16
    s_add_u32 s10, s10, s82
Lpad_0:
    s_cbranch_execz Lresume_0
    s_lshl_b32 s82, s31, 14
    s_add_u32 s10, s10, s82
    s_lshl_b32 s82, s76, 11
    s_add_u32 s10, s10, s82
    s_add_u32 s10, s10, 2097152
    v_lshlrev_b32 v15, 4, v1
    s_lshl_b32 s19, s77, 9
    s_lshl_b32 s82, s78, 4
    s_add_u32 s19, s19, s82
    s_lshl_b32 s82, s76, 2
    s_add_u32 s19, s19, s82
    s_add_u32 s19, s19, 4096
    v_cmp_eq_u32 vcc, 0, v1
    v_mov_b32 v60, 0
    s_mov_b32 s85, 0
    v_cndmask_b32 v59, v231, v60, vcc
    v_mov_b32 v81, v59
    s_mov_b32 s86, 0x05040100
    s_mov_b32 s87, 0x07060302
    s_mov_b32 s88, 0x3f803f80
    s_lshr_b32 s81, s78, 3
    s_lshl_b32 s5, s81, 12
    s_add_u32 s5, s5, s30
    s_lshl_b32 s4, s101, 6
    s_lshl_b32 s82, s76, 10
    s_add_u32 s4, s4, s82
    s_add_u32 s4, s4, s5
    v_bfe_u32 v61, v1, 2, 1
    v_lshlrev_b32 v61, 10, v61
    v_lshl_add_u32 v61, v226, 4, v61
    s_lshl_b32 s81, s101, 7
    s_add_u32 s81, s81, 131072
    v_add_u32 v3, s81, v61
    v_add_u32 v32, 131072, v32
    v_cmp_eq_u32 vcc, 63, v1
    s_lshl_b32 s81, s76, 3
    s_add_u32 s81, s81, 133120
    v_lshlrev_b32 v61, 3, v1
    v_add_u32 v61, 155904, v61
    v_mov_b32 v62, s81
    v_cndmask_b32 v39, v61, v62, vcc
    v_and_b32 v61, 1, v226
    v_lshlrev_b32 v61, 4, v61
    v_add_u32 v4, 133120, v61
    s_waitcnt lgkmcnt(0)
    s_memtime s[8:9]
    s_load_dword s11, s[32:33], s16
    v_and_b32 v61, 1, v226
    v_mul_u32_u24 v61, 3, v61
    v_lshrrev_b32 v62, 1, v226
    v_xor_b32 v230, v61, v62
    v_lshrrev_b32 v228, 2, v225
    v_and_b32 v229, 7, v1
    v_lshlrev_b32 v61, 9, v226
    v_cmp_gt_u32 vcc, 32, v1
    v_lshl_add_u32 v61, v225, 2, v61
    v_lshlrev_b32 v62, 6, v225
    v_cndmask_b32 v5, v231, v61, vcc
    v_lshl_add_u32 v6, v230, 4, v62
    s_lshl_b32 s81, s76, 15
    v_lshl_add_u32 v61, v227, 2, v228
    v_xor_b32 v61, v61, v230
    v_lshlrev_b32 v61, 4, v61
    v_lshl_add_u32 v61, v225, 8, v61
    v_add_u32 v61, s81, v61
    v_xor_b32 v212, 0, v61
    v_xor_b32 v213, 64, v61
    v_xor_b32 v214, 128, v61
    v_xor_b32 v215, 192, v61
    s_lshl_b32 s81, s76, 2
    v_lshlrev_b32 v61, 2, v228
    v_xor_b32 v61, s81, v61
    v_or_b32 v61, v61, v227
    v_lshlrev_b32 v61, 4, v61
    v_lshl_add_u32 v61, v228, 8, v61
    v_lshl_add_u32 v224, v226, 11, v61
    v_add_u32 v82, 133248, v224
    v_and_b32 v62, 17, v1
    v_cmp_eq_u32 vcc, 0, v62
    v_lshrrev_b32 v61, 5, v1
    v_lshlrev_b32 v61, 13, v61
    v_lshrrev_b32 v62, 3, v225
    v_xor_b32 v62, s76, v62
    v_and_b32 v62, 1, v62
    v_lshl_add_u32 v61, v62, 5, v61
    v_bfe_u32 v62, v1, 1, 1
    v_lshl_add_u32 v61, v62, 4, v61
    v_and_b32 v62, 4, v1
    v_add_u32 v61, v61, v62
    v_cndmask_b32 v7, v231, v61, vcc
    s_lshl_b32 s81, s76, 6
    v_xor_b32 v38, s81, v38
    v_and_b32 v61, 31, v1
    v_lshlrev_b32 v16, 3, v61
    v_cmp_lt_u32 s[28:29], 31, v1
    v_and_b32 v86, 1, v226
    v_mov_b32 v85, 4194304
    v_lshlrev_b32 v86, 9, v86
    v_cndmask_b32 v85, 0, v85, s[28:29]
    v_lshl_add_u32 v86, v225, 2, v86
    v_add_u32 v85, v85, v86
    v_mov_b32 v48, -1
    v_mov_b32 v49, -1
    v_mov_b32 v50, -1
    v_mov_b32 v51, -1
    buffer_store_dwordx4 v[48:51], v15, s[32:35], s10 offen offset:0 sc1
    buffer_store_dwordx4 v[48:51], v15, s[32:35], s10 offen offset:1024 sc1
    s_waitcnt lgkmcnt(0)
    s_memtime s[14:15]
    s_waitcnt lgkmcnt(0)
    s_sub_u32 s16, s14, s8
    s_mov_b32 m0, s22
    s_add_u32 s81, s21, s25
    buffer_load_dwordx4 v208, s[48:51], s81 offen offset:0 lds
    buffer_load_dwordx4 v209, s[48:51], s81 offen offset:1024 lds
    buffer_load_dwordx4 v210, s[48:51], s81 offen offset:2048 lds
    buffer_load_dwordx4 v211, s[48:51], s81 offen offset:3072 lds
    s_add_u32 s22, s22, 4096
    s_add_u32 s25, s25, 16384
    s_and_b32 s25, s25, 0x1ffff
    s_waitcnt vmcnt(15)
    ds_write_b64 v32, v[56:57]
    v_dot2_f32_bf16 v48, v56, s88, 0
    v_dot2_f32_bf16 v49, v56, v56, 0
    v_dot2_f32_bf16 v48, v57, s88, v48
    v_dot2_f32_bf16 v49, v57, v57, v49
    s_nop 1
    v_add_f32_dpp v48, v48, v48 row_ror:8
    v_add_f32_dpp v49, v49, v49 row_ror:8
    s_nop 0
    v_add_f32_dpp v48, v48, v48 row_ror:4
    v_add_f32_dpp v49, v49, v49 row_ror:4
    s_nop 0
    v_add_f32_dpp v48, v48, v48 row_ror:2
    v_add_f32_dpp v49, v49, v49 row_ror:2
    s_nop 0
    v_add_f32_dpp v48, v48, v48 row_ror:1
    v_add_f32_dpp v49, v49, v49 row_ror:1
    s_nop 0
    v_add_f32_dpp v48, v48, v48 row_bcast:15 row_mask:0xa
    v_add_f32_dpp v49, v49, v49 row_bcast:15 row_mask:0xa
    s_nop 0
    v_add_f32_dpp v48, v48, v48 row_bcast:31 row_mask:0xc
    v_add_f32_dpp v49, v49, v49 row_bcast:31 row_mask:0xc
    ds_write_b64 v39, v[48:49] offset:0
    v_readfirstlane_b32 s83, v79
    s_mul_i32 s83, s83, 1664525
    s_add_u32 s83, s83, 1013904223
    s_and_b32 s81, s83, 0xffffffe0
    s_or_b32 s81, s81, s89
    v_mov_b32 v46, s16
    ds_write_b32 v39, v46 offset:64
    v_mov_b32 v84, s83
    v_mov_b32 v80, s81
    v_cndmask_b32 v84, 0, v84, s[28:29]
    s_waitcnt vmcnt(11)
    s_waitcnt lgkmcnt(0)
    s_barrier
    ds_read_b64_tr_b16 v[112:113], v82 offset:0
    ds_read_b64_tr_b16 v[114:115], v82 offset:1024
    ds_read_b64_tr_b16 v[116:117], v82 offset:8
    ds_read_b64_tr_b16 v[118:119], v82 offset:1032
    ds_read_b64_tr_b16 v[120:121], v82 offset:8192
    ds_read_b64_tr_b16 v[122:123], v82 offset:9216
    ds_read_b64_tr_b16 v[124:125], v82 offset:8200
    ds_read_b64_tr_b16 v[126:127], v82 offset:9224
    ds_read_b128 v[60:63], v3
    ds_read_b128 v[64:67], v3 offset:64
    ds_read_b128 v[48:51], v4
    s_mov_b32 s81, 0x3b000000
    v_mov_b32 v68, s88
    v_mov_b32 v69, s88
    v_mov_b32 v70, s88
    v_mov_b32 v71, s88
    s_waitcnt lgkmcnt(3)
    s_nop 0
    v_mfma_f32_16x16x32_bf16 v[72:75], v[68:71], v[112:115], 0
    v_mfma_f32_16x16x32_bf16 v[76:79], v[68:71], v[116:119], 0
    v_mfma_f32_16x16x32_bf16 v[72:75], v[68:71], v[120:123], v[72:75]
    v_mfma_f32_16x16x32_bf16 v[76:79], v[68:71], v[124:127], v[76:79]
    s_waitcnt lgkmcnt(2)
    v_mfma_f32_16x16x32_bf16 v[52:55], v[60:63], v[112:115], 0
    v_mfma_f32_16x16x32_bf16 v[56:59], v[60:63], v[116:119], 0
    s_waitcnt lgkmcnt(1)
    v_mfma_f32_16x16x32_bf16 v[52:55], v[64:67], v[120:123], v[52:55]
    v_mfma_f32_16x16x32_bf16 v[56:59], v[64:67], v[124:127], v[56:59]
    s_waitcnt lgkmcnt(0)
    v_add_f32 v48, v48, v50
Lpad_1:
    s_cbranch_execz Lresume_0
    v_add_f32 v49, v49, v51
    v_mul_f32 v48, s81, v48
    v_mul_f32 v50, v48, v48
    v_fma_f32 v50, v49, s81, -v50
    v_max_f32 v50, 0, v50
    v_add_f32 v50, 0x3727c5ac, v50
    v_rsq_f32 v49, v50
    v_mov_b32 v27, v72
    v_mov_b32 v28, v76
    v_mul_f32 v49, 0x3e0293ee, v49
    v_fma_f32 v52, -v48, v27, v52
    v_fma_f32 v56, -v48, v28, v56
    v_mul_f32 v52, v49, v52
    v_mul_f32 v56, v49, v56
    v_cvt_pk_bf16_f32 v52, v52, v56
    v_xor_b32 v52, v52, v84
    buffer_store_dword v52, v85, s[32:35], s4 offen sc1
    v_mov_b32 v46, 133184
    ds_read2_b32 v[68:69], v46 offset0:4 offset1:6
    ds_read2_b32 v[46:47], v46 offset0:0 offset1:2
    s_bfe_u32 s81, s78, 0x10001
    s_xor_b32 s81, s81, s79
    s_waitcnt lgkmcnt(0)
    v_add_u32 v46, v46, v68
    v_add_u32 v47, v47, v69
    v_cmp_gt_u32 vcc, v46, v47
    s_nop 1
    v_cndmask_b32 v46, 0, 1, vcc
    v_xor_b32 v46, s81, v46
    v_lshl_or_b32 v80, v46, 4, v80
    s_lshl_b32 s24, s76, 10
    s_add_u32 s24, s24, s5
    v_add_u32 v45, 4194304, v6
    s_waitcnt vmcnt(5)
    s_waitcnt vmcnt(7)
    buffer_store_dword v80, v81, s[32:35], s19 offen sc1
    v_xor_b32 v208, 0x80, v208
    v_xor_b32 v209, 0x80, v209
    v_xor_b32 v210, 0x80, v210
    v_xor_b32 v211, 0x80, v211
    s_mov_b32 m0, s22
    s_add_u32 s81, s21, s25
    buffer_load_dwordx4 v208, s[48:51], s81 offen offset:0 lds
    buffer_load_dwordx4 v209, s[48:51], s81 offen offset:1024 lds
    buffer_load_dwordx4 v210, s[48:51], s81 offen offset:2048 lds
    buffer_load_dwordx4 v211, s[48:51], s81 offen offset:3072 lds
    s_add_u32 s22, s22, 4096
    s_add_u32 s25, s25, 16384
    s_and_b32 s25, s25, 0x1ffff
    s_xor_b32 s101, s79, 0
    s_lshl_b32 s7, s101, 13
    s_lshl_b32 s82, s31, 14
    s_add_u32 s7, s7, s82
    s_lshl_b32 s82, s76, 11
    s_add_u32 s7, s7, s82
    s_add_u32 s7, s7, 589824
    s_lshl_b32 s8, s101, 13
    s_lshl_b32 s82, s31, 11
    s_add_u32 s8, s8, s82
    s_lshl_b32 s82, s76, 9
    s_add_u32 s8, s8, s82
    s_lshl_b32 s82, s3, 3
    s_add_u32 s8, s8, s82
    s_add_u32 s8, s8, 786432
    s_xor_b32 s81, s101, 1
    s_lshl_b32 s9, s81, 13
    s_lshl_b32 s82, s31, 19
    s_add_u32 s9, s9, s82
    s_lshl_b32 s82, s76, 14
    s_add_u32 s9, s9, s82
    s_lshl_b32 s82, s3, 8
    s_add_u32 s9, s9, s82
    s_add_u32 s9, s9, 2097152
    s_lshl_b32 s81, s76, 15
    v_bfe_u32 v90, v1, 3, 1
    v_bfe_u32 v89, v1, 2, 1
    v_lshl_add_u32 v88, v89, 1, v90
    v_lshl_add_u32 v88, v88, 2, v226
    v_xor_b32 v88, v88, v227
    v_lshlrev_b32 v88, 4, v88
    v_lshl_add_u32 v88, v89, 12, v88
    v_lshl_add_u32 v89, v226, 2, v90
    v_lshl_add_u32 v88, v89, 8, v88
    v_and_b32 v89, 1, v1
    v_lshl_add_u32 v88, v89, 3, v88
    v_add_u32 v88, s81, v88
    v_xor_b32 v216, 0, v88
    v_xor_b32 v217, 8, v88
    v_xor_b32 v218, 64, v88
    v_xor_b32 v219, 72, v88
    v_xor_b32 v220, 128, v88
    v_xor_b32 v221, 136, v88
    v_xor_b32 v222, 192, v88
    v_xor_b32 v223, 200, v88
    v_and_b32 v90, 1, v1
    v_cmp_eq_u32 vcc, 0, v90
    v_lshlrev_b32 v90, 4, v90
    v_lshl_add_u32 v90, v226, 5, v90
    v_mov_b32 v2, 0x4444
    v_mov_b32 v89, 0xeeee
    v_cndmask_b32 v2, v89, v2, vcc
    v_lshrrev_b32 v89, 1, v225
    v_mul_u32_u24 v88, 320, v89
    v_lshl_add_u32 v8, v89, 6, v90
    v_add_u32 v88, v88, v90
    v_add_u32 v12, 149632, v88
    v_lshrrev_b32 v89, 1, v226
    v_mul_u32_u24 v88, 448, v89
    v_add_u32 v8, v88, v8
    v_lshlrev_b32 v88, 4, v225
    s_lshl_b32 s81, s76, 12
    s_add_u32 s81, s81, 133248
    v_lshl_add_u32 v89, v226, 10, v88
    v_add_u32 v9, s81, v89
    v_lshlrev_b32 v88, 3, v225
    v_lshl_add_u32 v14, v226, 17, v88
    s_lshl_b32 s81, s76, 10
    s_add_u32 s81, s81, 133248
    v_add_u32 v10, s81, v15
    v_lshrrev_b32 v88, 5, v1
    s_lshl_b32 s81, s76, 1
    v_add_u32 v88, s81, v88
    v_mul_u32_u24 v90, 320, v88
    v_and_b32 v88, 0x18, v1
    v_lshl_add_u32 v90, v88, 2, v90
    v_and_b32 v88, 6, v1
    v_lshl_add_u32 v90, v88, 1, v90
    v_and_b32 v88, 1, v1
    v_lshl_add_u32 v90, v88, 4, v90
    v_add_u32 v11, 149632, v90
    v_cmp_eq_u32 vcc, 0, v16
    v_lshlrev_b32 v88, 3, v1
    s_nop 0
    v_cndmask_b32 v13, v231, v88, vcc
    s_lshl_b32 s11, s101, 13
    s_lshl_b32 s82, s3, 8
    s_add_u32 s11, s11, s82
    s_add_u32 s11, s11, 786432
    s_lshl_b32 s23, s31, 20
    s_lshl_b32 s82, s3, 8
    s_add_u32 s23, s23, s82
    s_lshl_b32 s82, s76, 18
    s_add_u32 s23, s23, s82
    s_lshl_b32 s100, s76, 15
    s_lshr_b32 s81, s78, 2
    s_lshl_b32 s12, s81, 10
    s_lshl_b32 s82, s76, 8
    s_add_u32 s12, s12, s82
    s_lshl_b32 s82, s31, 6
    s_add_u32 s12, s12, s82
    s_add_u32 s12, s12, s30
    s_add_u32 s12, s12, 32768
    s_and_b32 s15, s78, 1
    s_lshr_b32 s81, s78, 1
    s_lshl_b32 s13, s15, 12
    s_lshl_b32 s82, s76, 10
    s_add_u32 s13, s13, s82
    s_add_u32 s13, s13, s30
    s_add_u32 s13, s13, 32768
    s_lshl_b32 s14, s101, 13
    s_lshl_b32 s82, s80, 11
    s_add_u32 s14, s14, s82
    s_lshl_b32 s82, s15, 10
    s_add_u32 s14, s14, s82
    s_lshl_b32 s82, s81, 6
    s_add_u32 s14, s14, s82
    s_add_u32 s14, s14, 720896
    s_lshl_b32 s15, s101, 13
    s_lshl_b32 s82, s76, 8
    s_add_u32 s15, s15, s82
    s_add_u32 s15, s15, 720896
    s_lshl_b32 s20, s79, 10
    s_lshl_b32 s82, s78, 5
    s_add_u32 s20, s20, s82
    s_lshl_b32 s18, s79, 12
    s_lshl_b32 s82, s80, 10
    s_add_u32 s18, s18, s82
    s_lshl_b32 s82, s78, 5
    s_add_u32 s18, s18, s82
    s_add_u32 s18, s18, 753664
    s_cmp_eq_u32 s76, 0
    s_cselect_b32 s18, s18, 1073741824
    s_cselect_b32 s14, s14, 1073741824
    s_and_b32 s81, s78, 28
    s_add_u32 s81, s81, s76
    s_lshl_b32 s16, s31, 2
    s_lshl_b32 s82, s81, 8
    s_add_u32 s16, s16, s82
    s_add_u32 s16, s16, s30
    s_add_u32 s16, s16, 49152
    s_cmp_eq_u32 s80, 3
    s_cselect_b32 s26, 20, 22
    s_cmp_lt_u32 s81, s26
    s_cselect_b32 s16, s16, 1073741824
    s_lshr_b32 s26, s26, 1
    s_lshl_b32 s17, s76, 11
    s_add_u32 s17, s17, s30
    s_add_u32 s17, s17, 49152
    s_lshl_b32 s81, s76, 2
    v_lshrrev_b32 v88, 1, v226
    v_bitop3_b32 v88, v88, v225, s81 bitop3:0x96
    v_and_b32 v89, 1, v226
    v_lshl_add_u32 v88, v88, 1, v89
Lpad_2:
    s_cbranch_execz Lresume_0
    v_lshlrev_b32 v17, 3, v88
    v_and_b32 v88, 1, v226
    v_lshlrev_b32 v88, 3, v88
    v_lshl_add_u32 v88, v225, 4, v88
    s_mul_i32 s81, s76, 288
    s_add_u32 s81, s81, 152192
    v_add_u32 v18, s81, v88
    v_mul_u32_u24 v88, 288, v227
    v_lshl_add_u32 v88, v226, 4, v88
    v_add_u32 v19, 152192, v88
    v_cmp_gt_u32 vcc, 16, v1
    v_lshlrev_b32 v90, 2, v1
    v_lshlrev_b32 v89, 6, v228
    v_cndmask_b32 v20, v231, v90, vcc
    v_lshl_add_u32 v89, v226, 4, v89
    v_lshl_add_u32 v26, v227, 2, v89
    v_lshlrev_b32 v89, 4, v226
    v_lshl_add_u32 v21, v225, 6, v89
    v_lshlrev_b32 v89, 4, v225
    v_lshl_add_u32 v25, v226, 11, v89
    v_and_b32 v88, 1, v226
    v_lshl_add_u32 v89, v88, 3, v89
    s_lshl_b32 s81, s79, 10
    s_lshl_b32 s82, s76, 8
    s_add_u32 s81, s81, s82
    s_add_u32 s81, s81, 131072
    v_add_u32 v34, s81, v89
    s_lshl_b32 s81, s76, 2
    v_add_u32 v88, s81, v228
    s_lshl_b32 s82, s26, 1
    s_lshl_b32 s81, s76, 3
    s_sub_i32 s29, s82, s81
    v_cmp_gt_i32 vcc, s29, v228
    v_add_u32 v90, 155904, v90
    v_lshlrev_b32 v89, 2, v26
    s_sub_i32 s29, s29, 4
    v_cndmask_b32 v26, v231, v89, vcc
    v_cmp_gt_i32 vcc, s29, v228
    v_add_u32 v89, 1024, v89
    s_nop 0
    v_cndmask_b32 v91, v231, v89, vcc
    s_lshl_b32 s81, s79, 10
    s_lshl_b32 s82, s31, 8
    s_add_u32 s81, s81, s82
    s_add_u32 s81, s81, 131072
    v_and_b32 v89, 1, v1
    v_lshl_add_u32 v89, v226, 1, v89
    v_lshl_add_u32 v33, v89, 4, s81
    v_cmp_eq_u32 vcc, v226, v228
    v_mul_u32_u24 v89, 320, v227
    v_lshl_add_u32 v89, v88, 2, v89
    v_add_u32 v89, 153344, v89
    v_cndmask_b32 v22, v90, v89, vcc
    v_mul_u32_u24 v88, 80, v225
    v_lshl_add_u32 v88, v226, 4, v88
    v_add_u32 v23, 153344, v88
    v_and_b32 v89, 0x31, v0
    v_cmp_eq_u32 vcc, 0, v89
    v_lshlrev_b32 v88, 1, v1
    v_and_b32 v89, 0x21, v0
    v_cndmask_b32 v24, v231, v88, vcc
    v_cmp_eq_u32 vcc, 0, v89
    v_and_b32 v90, 1, v1
    s_nop 0
    v_cndmask_b32 v35, v231, v88, vcc
    v_cmp_gt_u32 vcc, 16, v1
    s_lshl_b32 s81, s76, 2
    s_add_u32 s81, s81, 153344
    v_add_u32 v88, s81, v15
    v_lshlrev_b32 v89, 2, v1
    v_add_u32 v89, 155904, v89
    v_cndmask_b32 v36, v89, v88, vcc
    v_lshlrev_b32 v88, 1, v16
    v_add_u32 v37, 153344, v88
    v_lshlrev_b32 v88, 4, v90
    v_mov_b32 v89, 0xffff
    v_lshlrev_b32 v89, v88, v89
    v_lshrrev_b32 v88, 1, v229
    v_cmp_eq_u32 vcc, 0, v88
    s_nop 1
    v_cndmask_b32 v40, 0, v89, vcc
    v_cmp_eq_u32 vcc, 1, v88
    s_nop 1
    v_cndmask_b32 v41, 0, v89, vcc
    v_cmp_eq_u32 vcc, 2, v88
    s_nop 1
    v_cndmask_b32 v42, 0, v89, vcc
    v_cmp_eq_u32 vcc, 3, v88
    s_nop 1
    v_cndmask_b32 v43, 0, v89, vcc
    v_mov_b32 v16, v91
    v_xor_b32 v208, 0x80, v208
    v_xor_b32 v209, 0x80, v209
    v_xor_b32 v210, 0x80, v210
    v_xor_b32 v211, 0x80, v211
    s_mov_b32 m0, s22
    s_add_u32 s81, s21, s25
    buffer_load_dwordx4 v208, s[48:51], s81 offen offset:0 lds
    buffer_load_dwordx4 v209, s[48:51], s81 offen offset:1024 lds
    buffer_load_dwordx4 v210, s[48:51], s81 offen offset:2048 lds
    buffer_load_dwordx4 v211, s[48:51], s81 offen offset:3072 lds
    s_add_u32 s22, s22, 4096
    s_add_u32 s25, s25, 16384
    s_and_b32 s25, s25, 0x1ffff
    s_waitcnt vmcnt(10)
    ds_read_b128 a[0:3], v212 offset:0
    ds_read_b128 a[4:7], v213 offset:0
    ds_read_b128 a[8:11], v214 offset:0
    ds_read_b128 a[12:15], v215 offset:0
    s_waitcnt vmcnt(4)
    ds_read_b128 a[16:19], v214 offset:4096
    ds_read_b128 a[20:23], v215 offset:4096
    ds_read_b128 a[24:27], v212 offset:4096
    ds_read_b128 a[28:31], v213 offset:4096
    ds_read_b64_tr_b16 a[128:129], v216 offset:0
    ds_read_b64_tr_b16 a[130:131], v220 offset:512
    ds_read_b64_tr_b16 a[144:145], v217 offset:0
    ds_read_b64_tr_b16 a[146:147], v221 offset:512
    ds_read_b64_tr_b16 a[160:161], v218 offset:0
    ds_read_b64_tr_b16 a[162:163], v222 offset:512
    ds_read_b64_tr_b16 a[176:177], v219 offset:0
    ds_read_b64_tr_b16 a[178:179], v223 offset:512
    ds_read_b64_tr_b16 a[192:193], v220 offset:0
    ds_read_b64_tr_b16 a[194:195], v216 offset:512
    ds_read_b64_tr_b16 a[208:209], v221 offset:0
    ds_read_b64_tr_b16 a[210:211], v217 offset:512
    ds_read_b64_tr_b16 a[224:225], v222 offset:0
    ds_read_b64_tr_b16 a[226:227], v218 offset:512
    ds_read_b64_tr_b16 a[240:241], v223 offset:0
    ds_read_b64_tr_b16 a[242:243], v219 offset:512
    v_xor_b32 v208, 0x80, v208
    v_xor_b32 v209, 0x80, v209
    v_xor_b32 v210, 0x80, v210
    v_xor_b32 v211, 0x80, v211
    s_mov_b32 m0, s22
    s_add_u32 s81, s21, s25
    buffer_load_dwordx4 v208, s[48:51], s81 offen offset:0 lds
    buffer_load_dwordx4 v209, s[48:51], s81 offen offset:1024 lds
    buffer_load_dwordx4 v210, s[48:51], s81 offen offset:2048 lds
Lpad_3:
    s_cbranch_execz Lresume_0
    buffer_load_dwordx4 v211, s[48:51], s81 offen offset:3072 lds
    s_add_u32 s22, s22, 4096
    s_add_u32 s25, s25, 16384
    s_and_b32 s25, s25, 0x1ffff
    s_waitcnt vmcnt(21)
    ds_read_b128 v[128:131], v212 offset:28672
    ds_read_b128 v[132:135], v213 offset:28672
    ds_read_b128 v[136:139], v214 offset:28672
    ds_read_b128 v[140:143], v215 offset:28672
    s_waitcnt lgkmcnt(0)
    v_perm_b32 v96, v130, v128, s86
    v_perm_b32 v97, v130, v128, s87
    v_perm_b32 v98, v131, v129, s86
    v_perm_b32 v99, v131, v129, s87
    v_perm_b32 v100, v134, v132, s86
    v_perm_b32 v101, v134, v132, s87
    v_perm_b32 v102, v135, v133, s86
    v_perm_b32 v103, v135, v133, s87
    v_perm_b32 v104, v138, v136, s86
    v_perm_b32 v105, v138, v136, s87
    v_perm_b32 v106, v139, v137, s86
    v_perm_b32 v107, v139, v137, s87
    v_perm_b32 v108, v142, v140, s86
    v_perm_b32 v109, v142, v140, s87
    v_perm_b32 v110, v143, v141, s86
    v_perm_b32 v111, v143, v141, s87
    v_add_u32 v46, 149632, v15
    s_lshl_b32 s81, s76, 10
    v_add_u32 v47, s81, v46
    s_waitcnt vmcnt(13)
    buffer_load_dwordx4 v[52:55], v6, s[32:35], s24 offen sc1
    buffer_load_dwordx4 v[68:71], v45, s[32:35], s24 offen sc1
Lwarm_1:
    s_mov_b64 exec, 0
    s_cmp_eq_u32 s76, 0
    s_cbranch_scc1 Lpad_4
    s_cmp_eq_u32 s76, 1
    s_cbranch_scc1 Lpad_5
    s_cmp_eq_u32 s76, 2
    s_cbranch_scc1 Lpad_6
    s_branch Lpad_7
Lresume_1:
    s_mov_b64 exec, -1
    s_cmp_gt_u32 s85, 1048576
    s_branch Lbody_3
Lagain_2:
    buffer_load_dwordx4 v[52:55], v6, s[32:35], s24 offen sc1
    buffer_load_dwordx4 v[68:71], v45, s[32:35], s24 offen sc1
    s_add_u32 s85, s85, 1
    s_cmp_gt_u32 s85, 1048576
Lbody_3:
    s_waitcnt vmcnt(0)
    v_bitop3_b32 v68, v68, v52, s83 bitop3:0x96
    v_bitop3_b32 v69, v69, v53, s83 bitop3:0x96
    v_bitop3_b32 v70, v70, v54, s83 bitop3:0x96
    v_bitop3_b32 v71, v71, v55, s83 bitop3:0x96
    v_or3_b32 v44, v68, v69, v70
    v_or_b32 v44, v44, v71
    v_cmp_ne_u32 vcc, 0, v44
    s_cbranch_scc1 Lok_1
    s_cbranch_vccnz Lagain_2
Lok_1:
    ds_write_b128 v47, v[52:55]
    v_xor_b32 v208, 0x80, v208
    v_xor_b32 v209, 0x80, v209
    v_xor_b32 v210, 0x80, v210
    v_xor_b32 v211, 0x80, v211
    s_mov_b32 m0, s22
    s_add_u32 s81, s21, s25
    buffer_load_dwordx4 v208, s[48:51], s81 offen offset:0 lds
    buffer_load_dwordx4 v209, s[48:51], s81 offen offset:1024 lds
    buffer_load_dwordx4 v210, s[48:51], s81 offen offset:2048 lds
    buffer_load_dwordx4 v211, s[48:51], s81 offen offset:3072 lds
    s_add_u32 s22, s22, 4096
    s_add_u32 s25, s25, 16384
    s_and_b32 s25, s25, 0x1ffff
    s_waitcnt lgkmcnt(0)
    s_barrier
    ds_read_b128 v[52:55], v46 offset:0
    ds_read_b128 v[56:59], v46 offset:1024
    ds_read_b128 v[60:63], v46 offset:2048
    ds_read_b128 v[64:67], v46 offset:3072
    v_xor_b32 v208, 0x80, v208
    v_xor_b32 v209, 0x80, v209
    v_xor_b32 v210, 0x80, v210
    v_xor_b32 v211, 0x80, v211
    s_mov_b32 m0, s22
    s_add_u32 s81, s21, s25
    buffer_load_dwordx4 v208, s[48:51], s81 offen offset:0 lds
    buffer_load_dwordx4 v209, s[48:51], s81 offen offset:1024 lds
    buffer_load_dwordx4 v210, s[48:51], s81 offen offset:2048 lds
    buffer_load_dwordx4 v211, s[48:51], s81 offen offset:3072 lds
    s_add_u32 s22, s22, 4096
    s_add_u32 s25, s25, 16384
    s_and_b32 s25, s25, 0x1ffff
    s_waitcnt lgkmcnt(0)
    v_mfma_f32_16x16x32_bf16 v[48:51], v[52:55], v[96:99], 0
    v_mfma_f32_16x16x32_bf16 v[48:51], v[56:59], v[100:103], v[48:51]
    v_mfma_f32_16x16x32_bf16 v[48:51], v[60:63], v[104:107], v[48:51]
    v_mfma_f32_16x16x32_bf16 v[48:51], v[64:67], v[108:111], v[48:51]
    s_nop 7
    v_add_f32 v48, v48, v49
    v_add_f32 v50, v50, v51
    v_add_f32 v48, v48, v50
    v_mov_b32 v49, v48
    s_nop 1
    v_permlane16_swap_b32 v49, v48
    v_add_f32 v48, v48, v49
    s_nop 1
    v_mov_b32_dpp v49, v48 quad_perm:[1,1,3,3]
    v_cvt_pk_bf16_f32 v48, v48, v49
    buffer_store_dword v48, v7, s[32:35], s6 offen sc1
    v_xor_b32 v208, 0x80, v208
    v_xor_b32 v209, 0x80, v209
    v_xor_b32 v210, 0x80, v210
    v_xor_b32 v211, 0x80, v211
    s_mov_b32 m0, s22
    s_add_u32 s81, s21, s25
    buffer_load_dwordx4 v208, s[48:51], s81 offen offset:0 lds
    buffer_load_dwordx4 v209, s[48:51], s81 offen offset:1024 lds
    buffer_load_dwordx4 v210, s[48:51], s81 offen offset:2048 lds
    buffer_load_dwordx4 v211, s[48:51], s81 offen offset:3072 lds
    s_add_u32 s22, s22, 4096
    s_add_u32 s25, s25, 16384
    s_and_b32 s25, s25, 0x1ffff
    v_xor_b32 v208, 0x80, v208
    v_xor_b32 v209, 0x80, v209
    v_xor_b32 v210, 0x80, v210
    v_xor_b32 v211, 0x80, v211
    s_mov_b32 m0, s22
    s_add_u32 s81, s21, s25
    buffer_load_dwordx4 v208, s[48:51], s81 offen offset:0 lds
    buffer_load_dwordx4 v209, s[48:51], s81 offen offset:1024 lds
    buffer_load_dwordx4 v210, s[48:51], s81 offen offset:2048 lds
    buffer_load_dwordx4 v211, s[48:51], s81 offen offset:3072 lds
    s_add_u32 s22, s22, 4096
    s_add_u32 s25, s25, 16384
    s_and_b32 s25, s25, 0x1ffff
    v_lshlrev_b32 v77, 4, v0
    v_and_b32 v78, 0x1f0, v15
    s_lshl_b32 s27, s77, 9
    s_add_u32 s27, s27, 4096
    s_mov_b32 s28, 4096
    v_lshlrev_b32 v81, 6, v1
    buffer_load_dwordx4 v[72:75], v77, s[32:35], s28 offen sc1
    buffer_load_dword v76, v78, s[32:35], s27 offen sc1
    buffer_load_dword v82, v81, s[32:35], s28 offen sc1
    buffer_load_dword v83, v81, s[32:35], s28 offen offset:32 sc1
    s_waitcnt lgkmcnt(0)
    s_xor_b32 m0, s100, 0
    s_nop 0
    buffer_load_dwordx4 v38, s[52:55], s23 offen offset:0 lds
    s_add_u32 s23, s23, 31744
    s_xor_b32 m0, s100, 0
    s_nop 0
    buffer_load_dwordx4 v38, s[52:55], s23 offen offset:1024 lds
    s_add_u32 s23, s23, 31744
    s_xor_b32 m0, s100, 0
    s_nop 0
    buffer_load_dwordx4 v38, s[52:55], s23 offen offset:2048 lds
    s_add_u32 s23, s23, 31744
    s_waitcnt vmcnt(30)
    ds_read_b128 a[32:35], v212 offset:8192
    ds_read_b128 a[36:39], v213 offset:8192
    ds_read_b128 a[40:43], v214 offset:8192
    ds_read_b128 a[44:47], v215 offset:8192
Lpad_4:
    s_cbranch_execz Lresume_1
    s_waitcnt vmcnt(26)
    ds_read_b128 a[48:51], v214 offset:12288
    ds_read_b128 a[52:55], v215 offset:12288
    ds_read_b128 a[56:59], v212 offset:12288
    ds_read_b128 a[60:63], v213 offset:12288
    ds_read_b64_tr_b16 a[132:133], v216 offset:8192
    ds_read_b64_tr_b16 a[134:135], v220 offset:8704
    ds_read_b64_tr_b16 a[148:149], v217 offset:8192
    ds_read_b64_tr_b16 a[150:151], v221 offset:8704
    ds_read_b64_tr_b16 a[164:165], v218 offset:8192
    ds_read_b64_tr_b16 a[166:167], v222 offset:8704
    ds_read_b64_tr_b16 a[180:181], v219 offset:8192
    ds_read_b64_tr_b16 a[182:183], v223 offset:8704
    ds_read_b64_tr_b16 a[196:197], v220 offset:8192
    ds_read_b64_tr_b16 a[198:199], v216 offset:8704
    ds_read_b64_tr_b16 a[212:213], v221 offset:8192
    ds_read_b64_tr_b16 a[214:215], v217 offset:8704
    ds_read_b64_tr_b16 a[228:229], v222 offset:8192
    ds_read_b64_tr_b16 a[230:231], v218 offset:8704
    ds_read_b64_tr_b16 a[244:245], v223 offset:8192
    ds_read_b64_tr_b16 a[246:247], v219 offset:8704
    s_waitcnt vmcnt(20)
    ds_read_b128 a[64:67], v212 offset:16384
    ds_read_b128 a[68:71], v213 offset:16384
    ds_read_b128 a[72:75], v214 offset:16384
    ds_read_b128 a[76:79], v215 offset:16384
    s_waitcnt vmcnt(16)
    ds_read_b128 a[80:83], v214 offset:20480
    ds_read_b128 a[84:87], v215 offset:20480
    ds_read_b128 a[88:91], v212 offset:20480
    ds_read_b128 a[92:95], v213 offset:20480
    ds_read_b64_tr_b16 a[136:137], v216 offset:16384
    ds_read_b64_tr_b16 a[138:139], v220 offset:16896
    ds_read_b64_tr_b16 a[152:153], v217 offset:16384
    ds_read_b64_tr_b16 a[154:155], v221 offset:16896
    ds_read_b64_tr_b16 a[168:169], v218 offset:16384
    ds_read_b64_tr_b16 a[170:171], v222 offset:16896
    ds_read_b64_tr_b16 a[184:185], v219 offset:16384
    ds_read_b64_tr_b16 a[186:187], v223 offset:16896
    ds_read_b64_tr_b16 a[200:201], v220 offset:16384
    ds_read_b64_tr_b16 a[202:203], v216 offset:16896
    ds_read_b64_tr_b16 a[216:217], v221 offset:16384
    ds_read_b64_tr_b16 a[218:219], v217 offset:16896
    ds_read_b64_tr_b16 a[232:233], v222 offset:16384
    ds_read_b64_tr_b16 a[234:235], v218 offset:16896
    ds_read_b64_tr_b16 a[248:249], v223 offset:16384
    ds_read_b64_tr_b16 a[250:251], v219 offset:16896
    s_waitcnt vmcnt(11)
    ds_read_b128 a[96:99], v212 offset:24576
    ds_read_b128 a[100:103], v213 offset:24576
    ds_read_b128 a[104:107], v214 offset:24576
    ds_read_b128 a[108:111], v215 offset:24576
    s_waitcnt vmcnt(7)
    ds_read_b128 a[112:115], v214 offset:28672
    ds_read_b128 a[116:119], v215 offset:28672
    ds_read_b128 a[120:123], v212 offset:28672
    ds_read_b128 a[124:127], v213 offset:28672
    ds_read_b64_tr_b16 a[140:141], v216 offset:24576
    ds_read_b64_tr_b16 a[142:143], v220 offset:25088
    ds_read_b64_tr_b16 a[156:157], v217 offset:24576
    ds_read_b64_tr_b16 a[158:159], v221 offset:25088
    ds_read_b64_tr_b16 a[172:173], v218 offset:24576
    ds_read_b64_tr_b16 a[174:175], v222 offset:25088
    ds_read_b64_tr_b16 a[188:189], v219 offset:24576
    ds_read_b64_tr_b16 a[190:191], v223 offset:25088
    ds_read_b64_tr_b16 a[204:205], v220 offset:24576
    ds_read_b64_tr_b16 a[206:207], v216 offset:25088
    ds_read_b64_tr_b16 a[220:221], v221 offset:24576
    ds_read_b64_tr_b16 a[222:223], v217 offset:25088
    ds_read_b64_tr_b16 a[236:237], v222 offset:24576
    ds_read_b64_tr_b16 a[238:239], v218 offset:25088
    ds_read_b64_tr_b16 a[252:253], v223 offset:24576
    ds_read_b64_tr_b16 a[254:255], v219 offset:25088
    s_cmp_gt_u32 s85, 1048576
    s_branch Lbody_6
Lagain_5:
    s_mov_b64 exec, vcc
    buffer_load_dwordx4 v[72:75], v77, s[32:35], s28 offen sc1
    buffer_load_dword v76, v78, s[32:35], s27 offen sc1
    buffer_load_dword v82, v81, s[32:35], s28 offen sc1
    buffer_load_dword v83, v81, s[32:35], s28 offen offset:32 sc1
    s_mov_b64 exec, -1
    s_add_u32 s85, s85, 1
    s_cmp_gt_u32 s85, 1048576
    s_waitcnt vmcnt(0)
Lbody_6:
    s_waitcnt vmcnt(3)
    v_mov_b32 v44, 0
    v_xor_b32 v79, s83, v72
    v_lshrrev_b32 v79, 5, v79
    v_or_b32 v44, v44, v79
    v_xor_b32 v79, s83, v73
    v_lshrrev_b32 v79, 5, v79
    v_or_b32 v44, v44, v79
    v_xor_b32 v79, s83, v74
    v_lshrrev_b32 v79, 5, v79
    v_or_b32 v44, v44, v79
    v_xor_b32 v79, s83, v75
    v_lshrrev_b32 v79, 5, v79
    v_or_b32 v44, v44, v79
    v_xor_b32 v79, s83, v76
    v_lshrrev_b32 v79, 5, v79
    v_or_b32 v44, v44, v79
    v_xor_b32 v79, s83, v82
    v_lshrrev_b32 v79, 5, v79
    v_or_b32 v44, v44, v79
    v_xor_b32 v79, s83, v83
    v_lshrrev_b32 v79, 5, v79
    v_or_b32 v44, v44, v79
    v_cmp_ne_u32 vcc, 0, v44
    s_cbranch_scc1 Lok_4
    s_cbranch_vccnz Lagain_5
Lok_4:
    v_and_b32 v76, 15, v76
    v_cmp_ne_u32 vcc, s89, v76
    s_nop 4
    s_cmp_eq_u64 vcc, 0
    s_cselect_b32 s84, 1, 0
    s_mov_b32 s89, -2
    s_barrier
    s_mov_b32 s24, s7
    buffer_load_dwordx4 v[44:47], v8, s[32:35], s24 offen offset:0 sc1
    buffer_load_dwordx4 v[48:51], v8, s[32:35], s24 offen offset:1024 sc1
    s_waitcnt lgkmcnt(0)
    v_lshrrev_b32 v242, 2, v1
    v_bfe_u32 v243, v1, 4, 1
    v_lshlrev_b32 v243, 5, v243
    v_lshl_add_u32 v242, v242, 10, v243
    v_and_b32 v243, 0x30, v15
    v_xor_b32 v242, v242, v243
    s_and_b32 s81, s78, 1
    s_lshr_b32 s29, s78, 1
    s_lshl_b32 s29, s29, 6
    s_lshl_b32 s81, s81, 19
    s_lshl_b32 s82, s80, 20
    s_add_u32 s81, s81, s82
    s_lshl_b32 s82, s76, 17
    s_add_u32 s81, s81, s82
    s_add_u32 s29, s29, s81
    s_xor_b32 m0, s100, 16384
    s_nop 0
    buffer_load_dwordx4 v242, s[56:59], s29 offen offset:0 lds
    s_add_u32 s29, s29, 15360
    v_mov_b32 v72, s83
    s_cmp_eq_u32 s2, 0
    s_cselect_b32 s81, 0, 1073741824
    v_cmp_ne_u32 vcc, 0, v0
    s_nop 1
    v_cndmask_b32 v73, 0, 1, vcc
    v_lshlrev_b32 v73, 29, v73
    buffer_store_dword v72, v73, s[32:35], s81 offen sc1
    s_xor_b32 m0, s100, 0
    s_nop 0
    buffer_load_dwordx4 v38, s[52:55], s23 offen offset:3072 lds
    s_add_u32 s23, s23, 35840
    v_and_b32 v82, 16, v82
    v_cmp_ne_u32 vcc, 0, v82
    s_nop 4
    s_bcnt1_i32_b64 s81, vcc
    v_and_b32 v83, 16, v83
    v_cmp_ne_u32 vcc, 0, v83
    s_nop 4
    s_bcnt1_i32_b64 s82, vcc
    s_add_u32 s81, s81, s82
    s_cmp_gt_u32 s81, 64
    s_cselect_b32 s81, 8192, 0
    s_xor_b32 s7, s7, s81
    s_xor_b32 s8, s8, s81
    s_xor_b32 s11, s11, s81
    s_xor_b32 s9, s9, s81
    s_xor_b32 s10, s10, s81
    s_xor_b32 s14, s14, s81
    s_xor_b32 s15, s15, s81
    v_xor_b32 v7, s81, v7
    s_lshr_b32 s81, s81, 13
    s_xor_b32 s101, s101, s81
    s_branch Lbody_9
Lagain_8:
    s_mov_b64 exec, vcc
    buffer_load_dwordx4 v[44:47], v8, s[32:35], s24 offen offset:0 sc1
    buffer_load_dwordx4 v[48:51], v8, s[32:35], s24 offen offset:1024 sc1
    s_mov_b64 exec, -1
    s_add_u32 s85, s85, 1
    s_cmp_gt_u32 s85, 1048576
    s_cselect_b32 s89, -1, -2
    s_waitcnt vmcnt(0)
Lbody_9:
Lpad_5:
    s_cbranch_execz Lresume_1
    v_mov_b64 v[60:61], 0
    v_mov_b64 v[62:63], 0
    v_mov_b64 v[64:65], 0
    v_mov_b64 v[66:67], 0
    v_mov_b64 v[68:69], 0
    v_mov_b64 v[70:71], 0
    v_mov_b64 v[72:73], 0
    v_mov_b64 v[74:75], 0
    v_mov_b64 v[76:77], 0
    v_mov_b64 v[78:79], 0
    v_mov_b64 v[80:81], 0
    v_mov_b64 v[82:83], 0
    v_mov_b64 v[84:85], 0
    v_mov_b64 v[86:87], 0
    v_mov_b64 v[88:89], 0
    v_mov_b64 v[90:91], 0
    s_waitcnt lgkmcnt(0)
    s_waitcnt vmcnt(4)
    v_smfmac_f32_16x16x64_bf16 v[60:63], v[44:47], a[0:7], v2
    v_smfmac_f32_16x16x64_bf16 v[64:67], v[44:47], a[16:23], v2
    v_smfmac_f32_16x16x64_bf16 v[68:71], v[44:47], a[32:39], v2
    v_smfmac_f32_16x16x64_bf16 v[72:75], v[44:47], a[48:55], v2
    s_waitcnt vmcnt(3)
    v_smfmac_f32_16x16x64_bf16 v[60:63], v[48:51], a[8:15], v2
    v_max3_u32 v92, v44, v45, v46
    v_smfmac_f32_16x16x64_bf16 v[64:67], v[48:51], a[24:31], v2
    v_max3_u32 v92, v92, v47, v48
    v_smfmac_f32_16x16x64_bf16 v[68:71], v[48:51], a[40:47], v2
    v_max3_u32 v92, v92, v49, v50
    v_smfmac_f32_16x16x64_bf16 v[72:75], v[48:51], a[56:63], v2
    v_max_u32 v92, v92, v51
    v_cmp_lt_u32 vcc, s89, v92
    s_cbranch_vccnz Lagain_8
Lok_7:
    v_smfmac_f32_16x16x64_bf16 v[76:79], v[44:47], a[64:71], v2
    s_xor_b32 m0, s100, 4096
    s_nop 0
    buffer_load_dwordx4 v38, s[52:55], s23 offen offset:0 lds
    s_add_u32 s23, s23, 31744
    v_add_f32 v60, v60, v61
    v_smfmac_f32_16x16x64_bf16 v[76:79], v[48:51], a[72:79], v2
    s_xor_b32 m0, s100, 4096
    s_nop 0
    buffer_load_dwordx4 v38, s[52:55], s23 offen offset:1024 lds
    s_add_u32 s23, s23, 31744
    v_add_f32 v61, v62, v63
    v_smfmac_f32_16x16x64_bf16 v[80:83], v[44:47], a[80:87], v2
    s_xor_b32 m0, s100, 4096
    s_nop 0
    buffer_load_dwordx4 v38, s[52:55], s23 offen offset:2048 lds
    s_add_u32 s23, s23, 31744
    v_add_f32 v62, v64, v65
    v_smfmac_f32_16x16x64_bf16 v[80:83], v[48:51], a[88:95], v2
    s_xor_b32 m0, s100, 16384
    s_nop 0
    buffer_load_dwordx4 v242, s[56:59], s29 offen offset:1024 lds
    s_add_u32 s29, s29, 15360
    v_add_f32 v63, v66, v67
    v_smfmac_f32_16x16x64_bf16 v[84:87], v[44:47], a[96:103], v2
    s_xor_b32 m0, s100, 4096
    s_nop 0
    buffer_load_dwordx4 v38, s[52:55], s23 offen offset:3072 lds
    s_add_u32 s23, s23, 35840
    ds_write_b128 v9, v[60:63] offset:0
    v_smfmac_f32_16x16x64_bf16 v[84:87], v[48:51], a[104:111], v2
    v_add_f32 v68, v68, v69
    v_smfmac_f32_16x16x64_bf16 v[88:91], v[44:47], a[112:119], v2
    v_add_f32 v69, v70, v71
    v_smfmac_f32_16x16x64_bf16 v[88:91], v[48:51], a[120:127], v2
    v_add_f32 v70, v72, v73
    v_add_f32 v71, v74, v75
    ds_write_b128 v9, v[68:71] offset:256
    v_add_f32 v76, v76, v77
    v_add_f32 v77, v78, v79
    v_add_f32 v78, v80, v81
    v_add_f32 v79, v82, v83
    ds_write_b128 v9, v[76:79] offset:512
    v_add_f32 v84, v84, v85
    v_add_f32 v85, v86, v87
    v_add_f32 v86, v88, v89
    v_add_f32 v87, v90, v91
    ds_write_b128 v9, v[84:87] offset:768
    s_waitcnt lgkmcnt(0)
    s_barrier
    ds_read_b128 v[44:47], v10 offset:0
    ds_read_b128 v[48:51], v10 offset:4096
    ds_read_b128 v[52:55], v10 offset:8192
    ds_read_b128 v[56:59], v10 offset:12288
    v_mov_b64 v[60:61], 0
    v_mov_b64 v[62:63], 0
    v_mov_b64 v[64:65], 0
    v_mov_b64 v[66:67], 0
    v_mov_b64 v[68:69], 0
    v_mov_b64 v[70:71], 0
    v_mov_b64 v[72:73], 0
    v_mov_b64 v[74:75], 0
    v_mov_b64 v[76:77], 0
    v_mov_b64 v[78:79], 0
    v_mov_b64 v[80:81], 0
    v_mov_b64 v[82:83], 0
    v_mov_b64 v[84:85], 0
    v_mov_b64 v[86:87], 0
    v_mov_b64 v[88:89], 0
    v_mov_b64 v[90:91], 0
    s_waitcnt lgkmcnt(2)
    v_pk_add_f32 v[44:45], v[44:45], v[48:49]
    v_pk_add_f32 v[46:47], v[46:47], v[50:51]
    s_waitcnt lgkmcnt(0)
    v_pk_add_f32 v[52:53], v[52:53], v[56:57]
    v_pk_add_f32 v[54:55], v[54:55], v[58:59]
    v_pk_add_f32 v[44:45], v[44:45], v[52:53]
    v_pk_add_f32 v[46:47], v[46:47], v[54:55]
    s_nop 0
    v_permlane32_swap_b32 v44, v45
    v_permlane32_swap_b32 v46, v47
    v_max_f32 v92, v44, v45
    v_max3_f32 v92, v92, v46, v47
    s_nop 1
    v_max_f32_dpp v92, v92, v92 row_ror:8
    s_nop 1
    v_max_f32_dpp v92, v92, v92 row_ror:4
    s_nop 1
    v_max_f32_dpp v92, v92, v92 row_ror:2
    s_nop 1
    v_max_f32_dpp v92, v92, v92 row_ror:1
    v_mov_b32 v94, v92
    s_nop 1
    v_permlane16_swap_b32 v94, v92
    v_max_f32 v92, v92, v94
    v_pk_add_f32 v[44:45], v[44:45], v[92:93] op_sel_hi:[1,0] neg_lo:[0,1] neg_hi:[0,1]
    v_pk_add_f32 v[46:47], v[46:47], v[92:93] op_sel_hi:[1,0] neg_lo:[0,1] neg_hi:[0,1]
    v_exp_f32 v44, v44
    v_exp_f32 v46, v46
    v_exp_f32 v45, v45
    v_exp_f32 v47, v47
    v_cvt_pk_bf16_f32 v48, v44, v46
    v_cvt_pk_bf16_f32 v49, v45, v47
    ds_write2_b32 v11, v48, v49 offset0:0 offset1:32
    v_pk_add_f32 v[44:45], v[44:45], v[46:47]
    v_add_f32 v93, v44, v45
    s_nop 1
    v_add_f32_dpp v93, v93, v93 row_ror:8
    s_nop 1
    v_add_f32_dpp v93, v93, v93 row_ror:4
    s_nop 1
    v_add_f32_dpp v93, v93, v93 row_ror:2
    s_waitcnt lgkmcnt(0)
    s_barrier
    ds_read_b128 v[44:47], v12 offset:0
    ds_read_b128 v[48:51], v12 offset:128
    v_add_f32_dpp v93, v93, v93 row_ror:1
    v_mov_b32 v94, v93
    s_nop 1
    v_permlane16_swap_b32 v94, v93
    v_add_f32 v93, v93, v94
    buffer_store_dwordx2 v[92:93], v13, s[32:35], s8 offen sc1
    s_add_u32 s81, s9, 65536
    s_waitcnt lgkmcnt(0)
    v_smfmac_f32_16x16x64_bf16 v[60:63], v[44:47], a[128:135], v2
    v_smfmac_f32_16x16x64_bf16 v[60:63], v[48:51], a[136:143], v2
    v_smfmac_f32_16x16x64_bf16 v[64:67], v[44:47], a[144:151], v2
    v_smfmac_f32_16x16x64_bf16 v[64:67], v[48:51], a[152:159], v2
    v_smfmac_f32_16x16x64_bf16 v[68:71], v[44:47], a[160:167], v2
    v_smfmac_f32_16x16x64_bf16 v[68:71], v[48:51], a[168:175], v2
    v_smfmac_f32_16x16x64_bf16 v[72:75], v[44:47], a[176:183], v2
    v_smfmac_f32_16x16x64_bf16 v[72:75], v[48:51], a[184:191], v2
    s_nop 1
    v_add_f32 v60, v60, v61
    v_smfmac_f32_16x16x64_bf16 v[76:79], v[44:47], a[192:199], v2
    v_add_f32 v61, v62, v63
    v_smfmac_f32_16x16x64_bf16 v[76:79], v[48:51], a[200:207], v2
    v_add_f32 v64, v64, v65
    v_smfmac_f32_16x16x64_bf16 v[80:83], v[44:47], a[208:215], v2
    v_add_f32 v65, v66, v67
    v_smfmac_f32_16x16x64_bf16 v[80:83], v[48:51], a[216:223], v2
    v_cvt_pk_bf16_f32 v52, v60, v64
    v_cvt_pk_bf16_f32 v56, v61, v65
    v_smfmac_f32_16x16x64_bf16 v[84:87], v[44:47], a[224:231], v2
    v_add_f32 v68, v68, v69
    v_add_f32 v69, v70, v71
    v_smfmac_f32_16x16x64_bf16 v[84:87], v[48:51], a[232:239], v2
    v_add_f32 v72, v72, v73
    v_add_f32 v73, v74, v75
    v_smfmac_f32_16x16x64_bf16 v[88:91], v[44:47], a[240:247], v2
    v_cvt_pk_bf16_f32 v53, v68, v72
    v_cvt_pk_bf16_f32 v57, v69, v73
Lpad_6:
    s_cbranch_execz Lresume_1
    v_smfmac_f32_16x16x64_bf16 v[88:91], v[48:51], a[248:255], v2
    buffer_store_dwordx2 v[52:53], v14, s[32:35], s9 offen offset:0 sc1
    buffer_store_dwordx2 v[56:57], v14, s[32:35], s81 offen offset:0 sc1
    v_add_f32 v76, v76, v77
    v_add_f32 v77, v78, v79
    v_add_f32 v80, v80, v81
    v_add_f32 v81, v82, v83
    v_cvt_pk_bf16_f32 v54, v76, v80
    v_cvt_pk_bf16_f32 v58, v77, v81
    v_add_f32 v84, v84, v85
    v_add_f32 v85, v86, v87
    v_add_f32 v88, v88, v89
    v_add_f32 v89, v90, v91
    v_cvt_pk_bf16_f32 v55, v84, v88
    v_cvt_pk_bf16_f32 v59, v85, v89
    buffer_store_dwordx2 v[54:55], v14, s[32:35], s9 offen offset:128 sc1
    buffer_store_dwordx2 v[58:59], v14, s[32:35], s81 offen offset:128 sc1
    buffer_load_dword v252, v15, s[32:35], s13 offen offset:0 sc1
    s_xor_b32 m0, s100, 16384
    s_nop 0
    buffer_load_dwordx4 v242, s[56:59], s29 offen offset:2048 lds
    s_add_u32 s29, s29, 15360
Lwarm_2:
    s_mov_b64 exec, 0
    s_cmp_eq_u32 s76, 0
    s_cbranch_scc1 Lpad_8
    s_cmp_eq_u32 s76, 1
    s_cbranch_scc1 Lpad_9
    s_cmp_eq_u32 s76, 2
    s_cbranch_scc1 Lpad_10
    s_branch Lpad_11
Lresume_2:
    s_mov_b64 exec, -1
    v_lshrrev_b32 v244, 3, v1
    v_bfe_u32 v245, v1, 5, 1
    v_lshlrev_b32 v245, 1, v245
    v_and_b32 v246, 7, v1
    v_xor_b32 v245, v245, v246
    v_mul_u32_u24 v244, 2752, v244
    v_lshl_add_u32 v244, v245, 4, v244
    v_lshlrev_b32 v245, 4, v245
    v_xor_b32 v246, 64, v245
    v_sub_u32 v246, v246, v245
    v_add_u32 v245, v244, v246
    s_and_b32 s81, s78, 3
    s_lshr_b32 s25, s78, 2
    s_mul_i32 s21, s81, 352256
    s_mul_i32 s82, s76, 88064
    s_add_u32 s21, s21, s82
    s_mul_i32 s82, s80, 704
    s_add_u32 s21, s21, s82
    s_lshl_b32 s82, s25, 7
    s_add_u32 s21, s21, s82
    s_lshl_b32 s25, s25, 1
    s_cmp_lt_u32 s25, s26
    s_cselect_b32 s21, s21, 1073741824
    s_xor_b32 m0, s100, 8192
    s_mov_b32 s81, s21
    buffer_load_dwordx4 v244, s[60:63], s81 offen offset:0 lds
    s_add_u32 s81, s81, 20992
    buffer_load_dwordx4 v245, s[60:63], s81 offen offset:1024 lds
    s_add_u32 s81, s81, 20992
    buffer_load_dwordx4 v244, s[60:63], s81 offen offset:2048 lds
    s_add_u32 s81, s81, 20992
    buffer_load_dwordx4 v245, s[60:63], s81 offen offset:3072 lds
    s_xor_b32 m0, s100, 16384
    s_nop 0
    buffer_load_dwordx4 v242, s[56:59], s29 offen offset:3072 lds
    s_add_u32 s29, s29, 19456
    s_waitcnt vmcnt(12)
    s_waitcnt vmcnt(7)
    s_barrier
    buffer_load_dwordx2 v[52:53], v17, s[32:35], s11 offen sc1
    buffer_load_dwordx4 v[44:47], v15, s[32:35], s10 offen sc1
    buffer_load_dwordx4 v[48:51], v15, s[32:35], s10 offen offset:1024 sc1
    s_xor_b32 m0, s100, 20480
    s_nop 0
    buffer_load_dwordx4 v242, s[56:59], s29 offen offset:0 lds
    s_add_u32 s29, s29, 15360
    s_xor_b32 m0, s100, 20480
    s_nop 0
    buffer_load_dwordx4 v242, s[56:59], s29 offen offset:1024 lds
    s_add_u32 s29, s29, 15360
    v_bfe_u32 v88, v1, 3, 1
    v_bfe_u32 v89, v1, 4, 1
    v_lshlrev_b32 v89, 1, v89
    v_bitop3_b32 v84, v88, v89, s76 bitop3:0x96
    v_and_b32 v85, 3, v1
    v_lshl_add_u32 v84, v84, 2, v85
    v_lshlrev_b32 v84, 4, v84
    v_lshl_add_u32 v84, v88, 15, v84
    v_lshl_add_u32 v84, v89, 8, v84
    v_lshrrev_b32 v88, 5, v1
    v_mul_u32_u24 v88, 0xc00, v88
    v_and_b32 v89, 4, v1
    v_lshlrev_b32 v89, 8, v89
    v_bitop3_b32 v84, v84, v88, v89 bitop3:0x96
    v_xor_b32 v85, 0x140, v84
    v_xor_b32 v86, 0x10080, v84
    v_xor_b32 v87, 0x101c0, v84
    ds_read_b64_tr_b16 v[128:129], v84 offset:0
    ds_read_b64_tr_b16 v[130:131], v85 offset:0
    ds_read_b64_tr_b16 v[132:133], v84 offset:8
    ds_read_b64_tr_b16 v[134:135], v85 offset:8
    ds_read_b64_tr_b16 v[136:137], v84 offset:4096
    ds_read_b64_tr_b16 v[138:139], v85 offset:4096
    ds_read_b64_tr_b16 v[140:141], v84 offset:4104
    ds_read_b64_tr_b16 v[142:143], v85 offset:4104
    ds_read_b64_tr_b16 v[144:145], v86 offset:0
    ds_read_b64_tr_b16 v[146:147], v87 offset:0
    ds_read_b64_tr_b16 v[148:149], v86 offset:8
    ds_read_b64_tr_b16 v[150:151], v87 offset:8
    ds_read_b64_tr_b16 v[152:153], v86 offset:4096
    ds_read_b64_tr_b16 v[154:155], v87 offset:4096
    ds_read_b64_tr_b16 v[156:157], v86 offset:4104
    ds_read_b64_tr_b16 v[158:159], v87 offset:4104
    s_branch Lbody_12
Lagain_11:
    s_mov_b64 exec, vcc
    buffer_load_dwordx2 v[52:53], v17, s[32:35], s11 offen sc1
    buffer_load_dwordx4 v[44:47], v15, s[32:35], s10 offen sc1
    buffer_load_dwordx4 v[48:51], v15, s[32:35], s10 offen offset:1024 sc1
    s_mov_b64 exec, -1
    s_add_u32 s85, s85, 1
    s_cmp_gt_u32 s85, 1048576
    s_cselect_b32 s89, -1, -2
    s_waitcnt vmcnt(0)
Lbody_12:
    s_waitcnt vmcnt(4)
    v_max_f32_dpp v57, v52, v52 row_ror:8
    v_max_u32 v56, v52, v53
    s_nop 0
    v_max_f32_dpp v57, v57, v57 row_ror:4
    s_nop 1
    v_max_f32_dpp v57, v57, v57 row_ror:2
    s_nop 1
    v_max_f32_dpp v57, v57, v57 row_ror:1
Lpad_7:
    s_cbranch_execz Lresume_1
    v_mov_b32 v58, v57
    s_nop 1
    v_permlane16_swap_b32 v58, v57
    v_max_f32 v57, v57, v58
    v_sub_f32 v54, v52, v57
    v_exp_f32 v54, v54
    s_nop 0
    v_cvt_pk_bf16_f32 v54, v54, v54
    v_and_b32 v59, 0xffff0000, v54
    v_mul_f32 v59, v59, v53
    v_and_b32_dpp v60, v54, v40 row_newbcast:0
    v_and_b32_dpp v61, v54, v41 row_newbcast:0
    v_and_b32_dpp v62, v54, v42 row_newbcast:0
    v_and_b32_dpp v63, v54, v43 row_newbcast:0
    v_and_b32_dpp v64, v54, v40 row_newbcast:2
    v_and_b32_dpp v65, v54, v41 row_newbcast:2
    v_and_b32_dpp v66, v54, v42 row_newbcast:2
    v_and_b32_dpp v67, v54, v43 row_newbcast:2
    s_waitcnt vmcnt(3)
    v_mfma_f32_16x16x32_bf16 v[68:71], v[60:63], v[44:47], 0
    s_waitcnt vmcnt(2)
    v_mfma_f32_16x16x32_bf16 v[68:71], v[64:67], v[48:51], v[68:71]
    v_max3_u32 v56, v56, v44, v45
    v_max3_u32 v56, v56, v46, v47
    v_max3_u32 v56, v56, v48, v49
    v_max3_u32 v56, v56, v50, v51
    v_cmp_lt_u32 vcc, s89, v56
    s_cbranch_vccnz Lagain_11
Lok_10:
    s_xor_b32 m0, s100, 20480
    s_nop 0
    buffer_load_dwordx4 v242, s[56:59], s29 offen offset:2048 lds
    s_add_u32 s29, s29, 15360
    v_cvt_pk_bf16_f32 v68, v68, v69
    v_cvt_pk_bf16_f32 v69, v70, v71
    ds_write_b64 v18, v[68:69]
    s_cmp_lt_u32 s78, 24
    s_cbranch_scc1 Lpfd_13
    s_mul_i32 s81, s80, 360448
    s_mul_i32 s82, s78, 45056
    s_add_u32 s81, s81, s82
    s_mul_i32 s82, s76, 11264
    s_add_u32 s81, s81, s82
    s_add_u32 s81, s81, 4293885952
    buffer_load_dwordx4 v[252:255], v15, s[68:71], s81 offen offset:0
    buffer_load_dwordx4 v[252:255], v15, s[68:71], s81 offen offset:1024
    buffer_load_dwordx4 v[252:255], v15, s[68:71], s81 offen offset:2048
    buffer_load_dwordx4 v[252:255], v15, s[68:71], s81 offen offset:3072
    s_add_u32 s81, s81, 4096
    buffer_load_dwordx4 v[252:255], v15, s[68:71], s81 offen offset:0
    buffer_load_dwordx4 v[252:255], v15, s[68:71], s81 offen offset:1024
    buffer_load_dwordx4 v[252:255], v15, s[68:71], s81 offen offset:2048
    buffer_load_dwordx4 v[252:255], v15, s[68:71], s81 offen offset:3072
    s_add_u32 s81, s81, 4096
    buffer_load_dwordx4 v[252:255], v15, s[68:71], s81 offen offset:0
    buffer_load_dwordx4 v[252:255], v15, s[68:71], s81 offen offset:1024
    buffer_load_dwordx4 v[252:255], v15, s[68:71], s81 offen offset:2048
Lpfd_13:
    s_waitcnt lgkmcnt(0)
    s_barrier
    ds_read_b128 v[60:63], v19 offset:0
    ds_read_b128 v[64:67], v19 offset:64
    ds_read_b128 v[68:71], v19 offset:128
    ds_read_b128 v[72:75], v19 offset:192
    v_add_f32_dpp v59, v59, v59 row_ror:8
    s_nop 1
    v_add_f32_dpp v59, v59, v59 row_ror:4
    s_nop 1
    v_add_f32_dpp v59, v59, v59 row_ror:2
    s_nop 1
    v_add_f32_dpp v59, v59, v59 row_ror:1
    s_waitcnt lgkmcnt(3)
    v_mfma_f32_16x16x32_bf16 v[76:79], v[60:63], v[128:131], 0
    v_mfma_f32_16x16x32_bf16 v[80:83], v[60:63], v[132:135], 0
    s_waitcnt lgkmcnt(2)
    v_mfma_f32_16x16x32_bf16 v[76:79], v[64:67], v[136:139], v[76:79]
    v_mfma_f32_16x16x32_bf16 v[80:83], v[64:67], v[140:143], v[80:83]
    s_waitcnt lgkmcnt(1)
    v_mfma_f32_16x16x32_bf16 v[76:79], v[68:71], v[144:147], v[76:79]
    v_mfma_f32_16x16x32_bf16 v[80:83], v[68:71], v[148:151], v[80:83]
    s_waitcnt lgkmcnt(0)
    v_mfma_f32_16x16x32_bf16 v[76:79], v[72:75], v[152:155], v[76:79]
    v_mfma_f32_16x16x32_bf16 v[80:83], v[72:75], v[156:159], v[80:83]
    v_mov_b32 v57, v59
    s_nop 1
    v_permlane16_swap_b32 v57, v59
    v_add_f32 v59, v59, v57
    v_rcp_f32 v59, v59
    s_cmp_eq_u32 s84, 0
    v_pk_add_f32 v[76:77], v[76:77], v[78:79]
    v_pk_add_f32 v[80:81], v[80:81], v[82:83]
    v_add_f32 v76, v76, v77
    v_add_f32 v80, v80, v81
    v_mul_f32 v76, v76, v59
    v_mul_f32 v80, v80, v59
    v_cvt_pk_bf16_f32 v76, v76, v80
    s_cbranch_scc1 Lslow_14
    buffer_store_dword v76, v20, s[32:35], s12 offen
Lback_15:
    s_xor_b32 m0, s100, 20480
    s_nop 0
    buffer_load_dwordx4 v242, s[56:59], s29 offen offset:3072 lds
    s_add_u32 s29, s29, 19456
    s_waitcnt vmcnt(0)
    v_bfe_u32 v92, v1, 2, 1
    v_and_b32 v94, 3, v1
    v_lshl_add_u32 v93, v92, 2, v94
    v_lshrrev_b32 v94, 4, v1
    v_lshl_add_u32 v92, v94, 1, v92
    v_bfe_u32 v94, v1, 3, 1
    v_lshl_add_u32 v92, v92, 2, v94
    v_lshlrev_b32 v92, 6, v92
    v_lshl_add_u32 v92, v93, 3, v92
    s_lshl_b32 s81, s76, 15
    s_add_u32 s81, s81, 16384
    v_add_u32 v92, s81, v92
    v_xor_b32 v93, 32, v92
    ds_read_b64_tr_b16 v[192:193], v92 offset:0
    ds_read_b64_tr_b16 v[194:195], v92 offset:128
    ds_read_b64_tr_b16 v[196:197], v93 offset:0
    ds_read_b64_tr_b16 v[198:199], v93 offset:128
    ds_read_b64_tr_b16 v[200:201], v92 offset:2048
    ds_read_b64_tr_b16 v[202:203], v92 offset:2176
    ds_read_b64_tr_b16 v[204:205], v93 offset:2048
    ds_read_b64_tr_b16 v[206:207], v93 offset:2176
    ds_read_b64_tr_b16 v[208:209], v92 offset:4096
    ds_read_b64_tr_b16 v[210:211], v92 offset:4224
    ds_read_b64_tr_b16 v[212:213], v93 offset:4096
    ds_read_b64_tr_b16 v[214:215], v93 offset:4224
    ds_read_b64_tr_b16 v[216:217], v92 offset:6144
    ds_read_b64_tr_b16 v[218:219], v92 offset:6272
    ds_read_b64_tr_b16 v[220:221], v93 offset:6144
    ds_read_b64_tr_b16 v[222:223], v93 offset:6272
    s_waitcnt vmcnt(1)
    buffer_load_dwordx4 v[44:47], v21, s[32:35], s13 offen sc1
    s_branch Lbody_18
Lagain_17:
    s_mov_b64 exec, vcc
    buffer_load_dwordx4 v[44:47], v21, s[32:35], s13 offen sc1
    s_mov_b64 exec, -1
    s_add_u32 s85, s85, 1
    s_cmp_gt_u32 s85, 1048576
    s_cselect_b32 s89, -1, -2
Lbody_18:
    s_waitcnt lgkmcnt(0)
    s_waitcnt vmcnt(0)
    v_mfma_f32_16x16x32_bf16 v[60:63], v[44:47], v[192:195], 0
    v_mov_b32_dpp v48, v44 row_shl:4
    v_mov_b32_dpp v49, v45 row_shl:4
    v_mfma_f32_16x16x32_bf16 v[64:67], v[44:47], v[196:199], 0
    v_mov_b32_dpp v50, v46 row_shl:4
    v_mov_b32_dpp v51, v47 row_shl:4
    s_nop 1
    v_mfma_f32_16x16x32_bf16 v[60:63], v[48:51], v[200:203], v[60:63]
    v_mov_b32_dpp v52, v44 row_shl:8
    v_mov_b32_dpp v53, v45 row_shl:8
    v_mfma_f32_16x16x32_bf16 v[64:67], v[48:51], v[204:207], v[64:67]
    v_mov_b32_dpp v54, v46 row_shl:8
    v_mov_b32_dpp v55, v47 row_shl:8
    s_nop 1
    v_mfma_f32_16x16x32_bf16 v[60:63], v[52:55], v[208:211], v[60:63]
    v_mov_b32_dpp v56, v44 row_shl:12
    v_mov_b32_dpp v57, v45 row_shl:12
    v_mfma_f32_16x16x32_bf16 v[64:67], v[52:55], v[212:215], v[64:67]
    v_mov_b32_dpp v58, v46 row_shl:12
    v_mov_b32_dpp v59, v47 row_shl:12
    s_nop 1
    v_mfma_f32_16x16x32_bf16 v[60:63], v[56:59], v[216:219], v[60:63]
    v_mfma_f32_16x16x32_bf16 v[64:67], v[56:59], v[220:223], v[64:67]
Lpad_8:
    s_cbranch_execz Lresume_2
    v_max3_u32 v68, v44, v45, v46
    v_max_u32 v68, v68, v47
    v_cmp_lt_u32 vcc, s89, v68
    s_cbranch_vccnz Lagain_17
Lok_16:
    s_nop 2
    v_pk_add_f32 v[60:61], v[60:61], v[62:63]
    v_pk_add_f32 v[64:65], v[64:65], v[66:67]
    v_add_f32 v60, v60, v61
    v_add_f32 v64, v64, v65
    ds_write2_b32 v36, v60, v64 offset0:0 offset1:64
    s_waitcnt lgkmcnt(0)
    s_barrier
    ds_read_b128 v[44:47], v37
    s_waitcnt lgkmcnt(0)
    v_pk_add_f32 v[44:45], v[44:45], v[46:47]
    v_add_f32 v44, v44, v45
    s_nop 1
    v_mov_b32_dpp v45, v44 quad_perm:[1,1,3,3]
    v_cvt_pk_bf16_f32 v44, v44, v45
    buffer_store_dword v44, v35, s[32:35], s14 offen sc1
    s_xor_b32 m0, s100, 12288
    s_mov_b32 s81, s21
    buffer_load_dwordx4 v244, s[64:67], s81 offen offset:0 lds
    s_add_u32 s81, s81, 20992
    buffer_load_dwordx4 v245, s[64:67], s81 offen offset:1024 lds
    s_add_u32 s81, s81, 20992
    buffer_load_dwordx4 v244, s[64:67], s81 offen offset:2048 lds
    s_add_u32 s81, s81, 20992
    buffer_load_dwordx4 v245, s[64:67], s81 offen offset:3072 lds
    v_bfe_u32 v93, v0, 2, 2
    v_bfe_u32 v94, v0, 4, 2
    v_lshl_add_u32 v94, v93, 2, v94
    v_lshlrev_b32 v94, 12, v94
    v_and_b32 v93, 3, v0
    v_cmp_gt_u32 vcc, s34, v26
    v_lshl_add_u32 v95, v93, 3, v94
    s_mul_i32 s81, s80, 360448
    s_lshl_b32 s82, s76, 17
    s_add_u32 s81, s81, s82
    s_lshl_b32 s82, s78, 5
    s_add_u32 s81, s81, s82
    v_cndmask_b32 v93, v26, v95, vcc
    v_cmp_gt_u32 vcc, s34, v16
    s_add_u32 s82, s81, 65536
    s_nop 0
    v_cndmask_b32 v94, v16, v95, vcc
    buffer_load_dwordx2 v[240:241], v93, s[68:71], s81 offen offset:0
    buffer_load_dwordx2 v[242:243], v94, s[68:71], s82 offen offset:0
    buffer_load_dwordx2 v[244:245], v93, s[68:71], s81 offen offset:1024
    buffer_load_dwordx2 v[246:247], v94, s[68:71], s82 offen offset:1024
    buffer_load_dword v87, v26, s[32:35], s17 offen offset:0 sc1
    buffer_load_dword v87, v16, s[32:35], s17 offen offset:0 sc1
    ds_read_b64 v[72:73], v34
    v_and_b32 v68, s88, v40
    v_and_b32 v69, s88, v41
    v_and_b32 v70, s88, v42
    v_and_b32 v71, s88, v43
    s_waitcnt vmcnt(6)
    s_waitcnt lgkmcnt(0)
    v_and_b32 v75, 0xffff0000, v73
    v_lshlrev_b32 v74, 16, v73
    v_and_b32 v73, 0xffff0000, v72
    v_lshlrev_b32 v72, 16, v72
    s_waitcnt vmcnt(10)
    s_barrier
    buffer_load_dwordx4 v[44:47], v25, s[32:35], s15 offen offset:0 sc1
    buffer_load_dwordx4 v[48:51], v25, s[32:35], s15 offen offset:1024 sc1
    v_bfe_u32 v93, v0, 2, 2
    v_bfe_u32 v94, v0, 4, 2
    v_lshl_add_u32 v94, v93, 2, v94
    v_lshlrev_b32 v94, 12, v94
    v_and_b32 v93, 3, v0
    v_cmp_gt_u32 vcc, s34, v26
    v_lshl_add_u32 v95, v93, 3, v94
    s_mul_i32 s81, s80, 360448
    s_lshl_b32 s82, s76, 17
    s_add_u32 s81, s81, s82
    s_lshl_b32 s82, s78, 5
    s_add_u32 s81, s81, s82
    v_cndmask_b32 v93, v26, v95, vcc
    v_cmp_gt_u32 vcc, s34, v16
    s_add_u32 s82, s81, 65536
    s_nop 0
    v_cndmask_b32 v94, v16, v95, vcc
    buffer_load_dwordx2 v[248:249], v93, s[68:71], s81 offen offset:2048
    buffer_load_dwordx2 v[250:251], v94, s[68:71], s82 offen offset:2048
    buffer_load_dwordx2 v[252:253], v93, s[68:71], s81 offen offset:3072
    buffer_load_dwordx2 v[254:255], v94, s[68:71], s82 offen offset:3072
    v_bfe_u32 v93, v1, 4, 1
    v_bfe_u32 v94, v1, 3, 1
    v_lshl_add_u32 v93, v94, 1, v93
    v_xor_b32 v92, s76, v93
    v_and_b32 v94, 3, v1
    v_lshl_add_u32 v92, v92, 2, v94
    v_lshlrev_b32 v92, 3, v92
    v_lshl_add_u32 v92, v93, 9, v92
    v_lshrrev_b32 v93, 5, v1
    v_lshl_add_u32 v92, v93, 11, v92
    v_bfe_u32 v93, v1, 2, 1
    v_lshl_add_u32 v92, v93, 7, v92
    v_add_u32 v93, 0x10000, v92
    ds_read_b64_tr_b16 v[160:161], v92 offset:8192
    ds_read_b64_tr_b16 v[162:163], v92 offset:8448
    ds_read_b64_tr_b16 v[164:165], v92 offset:40960
    ds_read_b64_tr_b16 v[166:167], v92 offset:41216
    ds_read_b64_tr_b16 v[168:169], v93 offset:8192
    ds_read_b64_tr_b16 v[170:171], v93 offset:8448
    ds_read_b64_tr_b16 v[172:173], v93 offset:40960
    ds_read_b64_tr_b16 v[174:175], v93 offset:41216
    ds_read_b64_tr_b16 v[176:177], v92 offset:12288
    ds_read_b64_tr_b16 v[178:179], v92 offset:12544
    ds_read_b64_tr_b16 v[180:181], v92 offset:45056
    ds_read_b64_tr_b16 v[182:183], v92 offset:45312
    ds_read_b64_tr_b16 v[184:185], v93 offset:12288
    ds_read_b64_tr_b16 v[186:187], v93 offset:12544
    ds_read_b64_tr_b16 v[188:189], v93 offset:45056
    ds_read_b64_tr_b16 v[190:191], v93 offset:45312
    v_mov_b32 v64, s88
    v_mov_b32 v65, s88
    v_mov_b32 v66, s88
    v_mov_b32 v67, s88
    s_waitcnt lgkmcnt(0)
    s_nop 0
    v_mfma_f32_16x16x32_bf16 v[76:79], v[64:67], v[160:163], 0
    v_mfma_f32_16x16x32_bf16 v[80:83], v[64:67], v[176:179], 0
    v_mfma_f32_16x16x32_bf16 v[76:79], v[64:67], v[164:167], v[76:79]
    v_mfma_f32_16x16x32_bf16 v[80:83], v[64:67], v[180:183], v[80:83]
    v_mfma_f32_16x16x32_bf16 v[76:79], v[64:67], v[168:171], v[76:79]
    v_mfma_f32_16x16x32_bf16 v[80:83], v[64:67], v[184:187], v[80:83]
    v_mfma_f32_16x16x32_bf16 v[76:79], v[64:67], v[172:175], v[76:79]
    v_mfma_f32_16x16x32_bf16 v[80:83], v[64:67], v[188:191], v[80:83]
    s_nop 6
    v_mov_b32 v29, v76
    v_mov_b32 v30, v80
    s_mov_b32 s23, 0x00003f80
    s_mov_b32 s24, 0x3f800000
    v_mov_b32 v85, 133152
    v_mov_b64 v[76:77], 0
    v_mov_b64 v[78:79], 0
    v_mov_b64 v[80:81], 0
    v_mov_b64 v[82:83], 0
    s_branch Lbody_21
Lagain_20:
    s_mov_b64 exec, vcc
    buffer_load_dwordx4 v[44:47], v25, s[32:35], s15 offen offset:0 sc1
    buffer_load_dwordx4 v[48:51], v25, s[32:35], s15 offen offset:1024 sc1
    s_mov_b64 exec, -1
    s_add_u32 s85, s85, 1
    s_cmp_gt_u32 s85, 1048576
    s_cselect_b32 s89, -1, -2
    s_waitcnt vmcnt(0)
Lbody_21:
    s_waitcnt vmcnt(5)
    v_mfma_f32_16x16x32_bf16 v[52:55], v[68:71], v[44:47], v[72:75]
    s_waitcnt vmcnt(4)
    v_mfma_f32_16x16x32_bf16 v[52:55], v[68:71], v[48:51], v[52:55]
    v_max3_u32 v60, v44, v45, v46
    v_max3_u32 v60, v60, v47, v48
    v_max3_u32 v60, v60, v49, v50
    v_max_u32 v60, v60, v51
    v_cmp_lt_u32 vcc, s89, v60
    s_cbranch_vccnz Lagain_20
Lok_19:
    s_nop 1
    v_cvt_pk_bf16_f32 v52, v52, v53
    v_cvt_pk_bf16_f32 v53, v54, v55
    ds_write_b64 v34, v[52:53]
    v_dot2_f32_bf16 v88, v52, s88, 0
    v_dot2_f32_bf16 v89, v52, v52, 0
    v_dot2_f32_bf16 v88, v53, s88, v88
    v_dot2_f32_bf16 v89, v53, v53, v89
    s_nop 1
    v_add_f32_dpp v88, v88, v88 row_ror:8
    v_add_f32_dpp v89, v89, v89 row_ror:8
    s_nop 0
    v_add_f32_dpp v88, v88, v88 row_ror:4
Lpad_9:
    s_cbranch_execz Lresume_2
    v_add_f32_dpp v89, v89, v89 row_ror:4
    s_nop 0
    v_add_f32_dpp v88, v88, v88 row_ror:2
    v_add_f32_dpp v89, v89, v89 row_ror:2
    s_nop 0
    v_add_f32_dpp v88, v88, v88 row_ror:1
    v_add_f32_dpp v89, v89, v89 row_ror:1
    s_nop 0
    v_add_f32_dpp v88, v88, v88 row_bcast:15 row_mask:0xa
    v_add_f32_dpp v89, v89, v89 row_bcast:15 row_mask:0xa
    ds_write_b64 v39, v[88:89] offset:32
    s_waitcnt lgkmcnt(0)
    s_barrier
    ds_read_b128 v[44:47], v33 offset:0
    ds_read_b128 v[48:51], v33 offset:128
    ds_read_b128 v[60:63], v85
    ds_read_b128 v[64:67], v85 offset:16
    s_mov_b32 s81, 0x3b000000
    v_lshlrev_b32 v86, 2, v20
    v_max_u32 v86, v86, v20
    s_waitcnt lgkmcnt(3)
    v_smfmac_f32_16x16x64_bf16 v[76:79], v[44:47], v[160:167], v2
    v_smfmac_f32_16x16x64_bf16 v[80:83], v[44:47], v[176:183], v2
    s_waitcnt lgkmcnt(2)
    v_smfmac_f32_16x16x64_bf16 v[76:79], v[48:51], v[168:175], v2
    v_smfmac_f32_16x16x64_bf16 v[80:83], v[48:51], v[184:191], v2
    s_waitcnt lgkmcnt(0)
    v_add_f32 v60, v60, v64
    v_add_f32 v61, v61, v65
    v_add_f32 v62, v62, v66
    v_add_f32 v63, v63, v67
    v_add_f32 v60, v60, v62
    v_add_f32 v61, v61, v63
    v_mul_f32 v60, s81, v60
    v_mul_f32 v62, v60, v60
    v_fma_f32 v62, v61, s81, -v62
    v_max_f32 v62, 0, v62
    v_add_f32 v62, 0x3727c5ac, v62
    v_rsq_f32 v61, v62
    s_cmp_eq_u32 s84, 0
    v_add_f32 v76, v76, v77
    v_add_f32 v80, v80, v81
    v_fma_f32 v76, -v60, v29, v76
    v_fma_f32 v80, -v60, v30, v80
    v_mul_f32 v76, v61, v76
    v_mul_f32 v80, v61, v80
    v_cvt_pk_bf16_f32 v76, v76, v80
    s_cbranch_scc1 Lslow_22
    buffer_store_dword v76, v86, s[32:35], s16 offen
Lback_23:
    s_waitcnt vmcnt(1)
    v_perm_b32 v224, v242, v240, s86
    v_perm_b32 v225, v246, v244, s86
    v_perm_b32 v226, v250, v248, s86
    v_perm_b32 v227, v254, v252, s86
    v_perm_b32 v228, v242, v240, s87
    v_perm_b32 v229, v246, v244, s87
    v_perm_b32 v230, v250, v248, s87
    v_perm_b32 v231, v254, v252, s87
    v_perm_b32 v232, v243, v241, s86
    v_perm_b32 v233, v247, v245, s86
    v_perm_b32 v234, v251, v249, s86
    v_perm_b32 v235, v255, v253, s86
    v_perm_b32 v236, v243, v241, s87
    v_perm_b32 v237, v247, v245, s87
    v_perm_b32 v238, v251, v249, s87
    v_perm_b32 v239, v255, v253, s87
    v_and_b32 v84, 15, v1
    s_add_u32 s82, s20, 131072
    v_lshl_add_u32 v84, v84, 1, s82
    ds_read_u16 v84, v84
    s_cmp_eq_u32 s80, 0
    s_cselect_b32 s82, 0x10000, 0
    v_mov_b32 v88, 0xc0135761
    v_mov_b32 v89, 0xc0135761
    v_add_u32 v95, 1280, v22
    v_and_b32 v93, 0x11, v1
    v_cmp_eq_u32 vcc, 0, v93
    v_lshrrev_b32 v93, 5, v1
    v_mul_u32_u24 v93, 8128, v93
    v_lshl_add_u32 v93, v1, 1, v93
    v_mov_b32 v94, 1073741824
    v_cndmask_b32 v94, v94, v93, vcc
    s_waitcnt vmcnt(0)
    buffer_load_dwordx4 v[52:55], v26, s[32:35], s17 offen sc1
    buffer_load_dwordx4 v[56:59], v16, s[32:35], s17 offen sc1
    s_branch Lbody_26
Lagain_25:
    s_mov_b64 exec, vcc
    buffer_load_dwordx4 v[52:55], v26, s[32:35], s17 offen sc1
    buffer_load_dwordx4 v[56:59], v16, s[32:35], s17 offen sc1
    s_mov_b64 exec, -1
    s_add_u32 s85, s85, 1
    s_cmp_gt_u32 s85, 1048576
    s_cselect_b32 s89, -1, -2
Lbody_26:
    s_waitcnt vmcnt(0)
    v_dot2_f32_bf16 v60, v52, s23, 0
    v_dot2_f32_bf16 v61, v56, s23, 0
    v_dot2_f32_bf16 v62, v52, s24, 0
    v_dot2_f32_bf16 v63, v56, s24, 0
    v_dot2_f32_bf16 v60, v53, s23, v60
    v_dot2_f32_bf16 v61, v57, s23, v61
    v_dot2_f32_bf16 v62, v53, s24, v62
    v_dot2_f32_bf16 v63, v57, s24, v63
    v_dot2_f32_bf16 v60, v54, s23, v60
    v_dot2_f32_bf16 v61, v58, s23, v61
    v_dot2_f32_bf16 v62, v54, s24, v62
    v_dot2_f32_bf16 v63, v58, s24, v63
    v_dot2_f32_bf16 v60, v55, s23, v60
    v_dot2_f32_bf16 v61, v59, s23, v61
    v_dot2_f32_bf16 v62, v55, s24, v62
    v_dot2_f32_bf16 v63, v59, s24, v63
    v_max3_u32 v64, v52, v53, v54
    v_max3_u32 v64, v64, v55, v56
    v_max3_u32 v64, v64, v57, v58
    v_max_u32 v64, v64, v59
    v_cmp_lt_u32 vcc, s89, v64
    s_cbranch_vccnz Lagain_25
Lok_24:
    v_mul_f32 v90, v60, v60
    v_mul_f32 v91, v61, v61
    v_fmac_f32 v88, 0xbdd2d3e8, v90
    v_fmac_f32 v89, 0xbdd2d3e8, v91
    v_mul_f32 v88, v88, v60
    v_mul_f32 v89, v89, v61
    v_exp_f32 v88, v88
    v_exp_f32 v89, v89
    v_mul_f32 v60, v60, v62
    v_mul_f32 v61, v61, v63
    v_add_f32 v88, 1.0, v88
    v_add_f32 v89, 1.0, v89
    v_rcp_f32 v88, v88
    v_rcp_f32 v89, v89
    v_mul_f32 v60, v60, v88
    v_mul_f32 v61, v61, v89
    v_cvt_pk_bf16_f32 v60, v60, v61
    s_nop 1
    v_mov_b32_dpp v44, v60 quad_perm:[0,0,0,0]
    v_mov_b32_dpp v45, v60 quad_perm:[1,1,1,1]
    v_mov_b32_dpp v46, v60 quad_perm:[2,2,2,2]
    v_mov_b32_dpp v47, v60 quad_perm:[3,3,3,3]
    s_nop 1
    v_mfma_f32_16x16x32_bf16 v[68:71], v[44:47], v[224:227], 0
    v_mfma_f32_16x16x32_bf16 v[72:75], v[44:47], v[228:231], 0
    v_mfma_f32_16x16x32_bf16 v[76:79], v[44:47], v[232:235], 0
    v_mfma_f32_16x16x32_bf16 v[80:83], v[44:47], v[236:239], 0
    s_nop 5
    ds_write2_b32 v95, v68, v72 offset0:0 offset1:20
    s_nop 0
    ds_write2_b32 v95, v76, v80 offset0:40 offset1:60
    s_waitcnt lgkmcnt(0)
    s_barrier
    ds_read_b128 v[44:47], v23 offset:1280
    v_mul_u32_u24 v84, s82, v84
    s_waitcnt lgkmcnt(0)
    v_pk_add_f32 v[44:45], v[44:45], v[46:47]
    v_add_f32 v44, v44, v45
    v_mov_b32 v45, v44
    s_nop 1
    v_permlane16_swap_b32 v45, v44
    v_add_f32 v44, v44, v45
    v_mov_b32 v45, v44
    s_nop 1
    v_permlane32_swap_b32 v45, v44
    v_add_f32 v44, v44, v45
    v_add_f32 v84, v84, v44
    s_nop 1
    v_mov_b32_dpp v45, v84 quad_perm:[1,1,3,3]
    v_cvt_pk_bf16_f32 v44, v84, v45
    buffer_store_dword v44, v94, s[32:35], s18 offen sc1
    v_mov_b32 v88, -1
    v_mov_b32 v89, -1
    v_mov_b32 v90, -1
    v_mov_b32 v91, -1
    buffer_store_dwordx4 v[88:91], v15, s[32:35], s10 offen offset:0 sc1
    buffer_store_dwordx4 v[88:91], v15, s[32:35], s10 offen offset:1024 sc1
Lwarm_3:
    s_mov_b64 exec, 0
    s_cmp_eq_u32 s76, 0
    s_cbranch_scc1 Lpad_12
    s_cmp_eq_u32 s76, 1
    s_cbranch_scc1 Lpad_13
    s_cmp_eq_u32 s76, 2
    s_cbranch_scc1 Lpad_14
    s_branch Lresume_3
Lresume_3:
    s_mov_b64 exec, -1
Lpad_10:
    s_cbranch_execz Lresume_2
    s_lshl_b32 s81, s101, 13
    s_add_u32 s18, s18, s81
    s_lshl_b32 s19, s101, 13
    s_add_u32 s19, s19, 753664
    s_add_u32 s4, s4, 16384
    s_add_u32 s5, s5, 16384
    s_add_u32 s6, s6, 65536
    s_add_u32 s7, s7, 65536
    s_add_u32 s8, s8, 16384
    s_add_u32 s11, s11, 16384
    s_add_u32 s12, s12, 8192
    s_add_u32 s13, s13, 8192
    s_add_u32 s14, s14, 16384
    s_add_u32 s15, s15, 16384
    s_add_u32 s16, s16, 6144
    s_add_u32 s17, s17, 6144
    s_add_u32 s18, s18, 16384
    v_lshrrev_b32 v84, 7, v0
    v_mul_u32_u24 v84, 3072, v84
    v_lshl_add_u32 v84, v0, 3, v84
    buffer_load_dword v252, v15, s[32:35], s5 offen offset:0 sc1
    buffer_load_dword v252, v15, s[32:35], s5 offen offset:1024 sc1
    buffer_load_dword v252, v15, s[32:35], s5 offen offset:2048 sc1
    buffer_load_dword v252, v15, s[32:35], s5 offen offset:3072 sc1
    s_waitcnt vmcnt(6)
    s_barrier
    buffer_load_dwordx2 v[56:57], v84, s[32:35], s19 offen offset:0 sc1
    buffer_load_dwordx2 v[58:59], v84, s[32:35], s19 offen offset:1024 sc1
    buffer_load_dwordx2 v[60:61], v84, s[32:35], s19 offen offset:2048 sc1
    buffer_load_dwordx2 v[62:63], v84, s[32:35], s19 offen offset:3072 sc1
    s_branch Lbody_29
Lagain_28:
    s_mov_b64 exec, vcc
    buffer_load_dwordx2 v[56:57], v84, s[32:35], s19 offen offset:0 sc1
    buffer_load_dwordx2 v[58:59], v84, s[32:35], s19 offen offset:1024 sc1
    buffer_load_dwordx2 v[60:61], v84, s[32:35], s19 offen offset:2048 sc1
    buffer_load_dwordx2 v[62:63], v84, s[32:35], s19 offen offset:3072 sc1
    s_mov_b64 exec, -1
    s_add_u32 s85, s85, 1
    s_cmp_gt_u32 s85, 1048576
    s_cselect_b32 s89, -1, -2
Lbody_29:
    s_waitcnt vmcnt(3)
    v_dot2_f32_bf16 v64, v56, s23, 0
    v_dot2_f32_bf16 v65, v56, s24, 0
    v_dot2_f32_bf16 v66, v57, s23, 0
    v_dot2_f32_bf16 v67, v57, s24, 0
    s_waitcnt vmcnt(2)
    v_dot2_f32_bf16 v64, v58, s23, v64
    v_dot2_f32_bf16 v65, v58, s24, v65
    v_dot2_f32_bf16 v66, v59, s23, v66
    v_dot2_f32_bf16 v67, v59, s24, v67
    s_waitcnt vmcnt(1)
    v_dot2_f32_bf16 v64, v60, s23, v64
    v_dot2_f32_bf16 v65, v60, s24, v65
    v_dot2_f32_bf16 v66, v61, s23, v66
    v_dot2_f32_bf16 v67, v61, s24, v67
    s_waitcnt vmcnt(0)
    v_dot2_f32_bf16 v64, v62, s23, v64
    v_dot2_f32_bf16 v65, v62, s24, v65
    v_dot2_f32_bf16 v66, v63, s23, v66
    v_dot2_f32_bf16 v67, v63, s24, v67
    v_max3_u32 v68, v56, v57, v58
    v_max3_u32 v68, v68, v59, v60
    v_max3_u32 v68, v68, v61, v62
    v_max_u32 v68, v68, v63
    v_cmp_lt_u32 vcc, s89, v68
    s_cbranch_vccnz Lagain_28
Lok_27:
    v_cvt_pk_bf16_f32 v56, v64, v65
    v_cvt_pk_bf16_f32 v57, v66, v67
    ds_write_b64 v32, v[56:57]
    v_dot2_f32_bf16 v48, v56, s88, 0
    v_dot2_f32_bf16 v49, v56, v56, 0
    v_dot2_f32_bf16 v48, v57, s88, v48
    v_dot2_f32_bf16 v49, v57, v57, v49
    s_nop 1
    v_add_f32_dpp v48, v48, v48 row_ror:8
    v_add_f32_dpp v49, v49, v49 row_ror:8
    s_nop 0
    v_add_f32_dpp v48, v48, v48 row_ror:4
    v_add_f32_dpp v49, v49, v49 row_ror:4
    s_nop 0
    v_add_f32_dpp v48, v48, v48 row_ror:2
    v_add_f32_dpp v49, v49, v49 row_ror:2
    s_nop 0
    v_add_f32_dpp v48, v48, v48 row_ror:1
    v_add_f32_dpp v49, v49, v49 row_ror:1
    s_nop 0
    v_add_f32_dpp v48, v48, v48 row_bcast:15 row_mask:0xa
    v_add_f32_dpp v49, v49, v49 row_bcast:15 row_mask:0xa
    s_nop 0
    v_add_f32_dpp v48, v48, v48 row_bcast:31 row_mask:0xc
    v_add_f32_dpp v49, v49, v49 row_bcast:31 row_mask:0xc
    ds_write_b64 v39, v[48:49] offset:0
    s_waitcnt lgkmcnt(0)
    s_barrier
    ds_read_b128 v[60:63], v3
    ds_read_b128 v[64:67], v3 offset:64
    ds_read_b128 v[48:51], v4
    s_mov_b32 s81, 0x3b000000
    s_waitcnt lgkmcnt(2)
    v_mfma_f32_16x16x32_bf16 v[52:55], v[60:63], v[112:115], 0
    v_mfma_f32_16x16x32_bf16 v[56:59], v[60:63], v[116:119], 0
    s_waitcnt lgkmcnt(1)
    v_mfma_f32_16x16x32_bf16 v[52:55], v[64:67], v[120:123], v[52:55]
    v_mfma_f32_16x16x32_bf16 v[56:59], v[64:67], v[124:127], v[56:59]
    s_waitcnt lgkmcnt(0)
    v_add_f32 v48, v48, v50
    v_add_f32 v49, v49, v51
    v_mul_f32 v48, s81, v48
    v_mul_f32 v50, v48, v48
    v_fma_f32 v50, v49, s81, -v50
    v_max_f32 v50, 0, v50
    v_add_f32 v50, 0x3727c5ac, v50
    v_rsq_f32 v49, v50
    s_cmp_eq_u32 s84, 0
    v_mul_f32 v49, 0x3e0293ee, v49
    v_fma_f32 v52, -v48, v27, v52
    v_fma_f32 v56, -v48, v28, v56
    v_mul_f32 v52, v49, v52
    v_mul_f32 v56, v49, v56
    v_cvt_pk_bf16_f32 v52, v52, v56
    s_cbranch_scc1 Lslow_30
    buffer_store_dword v52, v5, s[32:35], s4 offen
Lback_31:
Lpad_11:
    s_cbranch_execz Lresume_2
    s_waitcnt vmcnt(0)
    s_lshl_b32 s81, s76, 10
    s_add_u32 s81, s81, s5
    buffer_load_dwordx4 v[52:55], v6, s[32:35], s81 offen sc1
    v_add_u32 v46, 149632, v15
    s_lshl_b32 s82, s76, 10
    v_add_u32 v47, s82, v46
    s_branch Lbody_34
Lagain_33:
    s_mov_b64 exec, vcc
    buffer_load_dwordx4 v[52:55], v6, s[32:35], s81 offen sc1
    s_mov_b64 exec, -1
    s_add_u32 s85, s85, 1
    s_cmp_gt_u32 s85, 1048576
    s_cselect_b32 s89, -1, -2
Lbody_34:
    s_waitcnt vmcnt(0)
    ds_write_b128 v47, v[52:55]
    v_max3_u32 v44, v52, v53, v54
    v_max_u32 v44, v44, v55
    v_cmp_lt_u32 vcc, s89, v44
    s_cbranch_vccnz Lagain_33
Lok_32:
    s_waitcnt lgkmcnt(0)
    s_barrier
    ds_read_b128 v[52:55], v46 offset:0
    ds_read_b128 v[56:59], v46 offset:1024
    ds_read_b128 v[60:63], v46 offset:2048
    ds_read_b128 v[64:67], v46 offset:3072
    s_waitcnt lgkmcnt(3)
    v_mfma_f32_16x16x32_bf16 v[48:51], v[52:55], v[96:99], 0
    s_waitcnt lgkmcnt(2)
    v_mfma_f32_16x16x32_bf16 v[48:51], v[56:59], v[100:103], v[48:51]
    s_waitcnt lgkmcnt(1)
    v_mfma_f32_16x16x32_bf16 v[48:51], v[60:63], v[104:107], v[48:51]
    s_waitcnt lgkmcnt(0)
    v_mfma_f32_16x16x32_bf16 v[48:51], v[64:67], v[108:111], v[48:51]
    s_nop 7
    v_add_f32 v48, v48, v49
    v_add_f32 v50, v50, v51
    v_add_f32 v48, v48, v50
    v_mov_b32 v49, v48
    s_nop 1
    v_permlane16_swap_b32 v49, v48
    v_add_f32 v48, v48, v49
    s_nop 1
    v_mov_b32_dpp v49, v48 quad_perm:[1,1,3,3]
    v_cvt_pk_bf16_f32 v48, v48, v49
    buffer_store_dword v48, v7, s[32:35], s6 offen sc1
    s_waitcnt vmcnt(0)
    s_barrier
    buffer_load_dwordx4 v[44:47], v8, s[32:35], s7 offen offset:0 sc1
    buffer_load_dwordx4 v[48:51], v8, s[32:35], s7 offen offset:1024 sc1
    s_branch Lbody_37
Lagain_36:
    s_mov_b64 exec, vcc
    buffer_load_dwordx4 v[44:47], v8, s[32:35], s7 offen offset:0 sc1
    buffer_load_dwordx4 v[48:51], v8, s[32:35], s7 offen offset:1024 sc1
    s_mov_b64 exec, -1
    s_add_u32 s85, s85, 1
    s_cmp_gt_u32 s85, 1048576
    s_cselect_b32 s89, -1, -2
Lbody_37:
    v_mov_b64 v[60:61], 0
    v_mov_b64 v[62:63], 0
    v_mov_b64 v[64:65], 0
    v_mov_b64 v[66:67], 0
    v_mov_b64 v[68:69], 0
    v_mov_b64 v[70:71], 0
    v_mov_b64 v[72:73], 0
    v_mov_b64 v[74:75], 0
    v_mov_b64 v[76:77], 0
    v_mov_b64 v[78:79], 0
    v_mov_b64 v[80:81], 0
    v_mov_b64 v[82:83], 0
    v_mov_b64 v[84:85], 0
    v_mov_b64 v[86:87], 0
    v_mov_b64 v[88:89], 0
    v_mov_b64 v[90:91], 0
    s_waitcnt vmcnt(1)
    v_smfmac_f32_16x16x64_bf16 v[60:63], v[44:47], a[0:7], v2
    v_smfmac_f32_16x16x64_bf16 v[64:67], v[44:47], a[16:23], v2
    v_smfmac_f32_16x16x64_bf16 v[68:71], v[44:47], a[32:39], v2
    v_smfmac_f32_16x16x64_bf16 v[72:75], v[44:47], a[48:55], v2
    s_waitcnt vmcnt(0)
    v_smfmac_f32_16x16x64_bf16 v[60:63], v[48:51], a[8:15], v2
    v_max3_u32 v92, v44, v45, v46
    v_smfmac_f32_16x16x64_bf16 v[64:67], v[48:51], a[24:31], v2
    v_max3_u32 v92, v92, v47, v48
    v_smfmac_f32_16x16x64_bf16 v[68:71], v[48:51], a[40:47], v2
    v_max3_u32 v92, v92, v49, v50
    v_smfmac_f32_16x16x64_bf16 v[72:75], v[48:51], a[56:63], v2
    v_max_u32 v92, v92, v51
    v_cmp_lt_u32 vcc, s89, v92
    s_cbranch_vccnz Lagain_36
Lok_35:
    v_smfmac_f32_16x16x64_bf16 v[76:79], v[44:47], a[64:71], v2
    v_add_f32 v60, v60, v61
    v_smfmac_f32_16x16x64_bf16 v[76:79], v[48:51], a[72:79], v2
    v_add_f32 v61, v62, v63
    v_smfmac_f32_16x16x64_bf16 v[80:83], v[44:47], a[80:87], v2
    v_add_f32 v62, v64, v65
    v_smfmac_f32_16x16x64_bf16 v[80:83], v[48:51], a[88:95], v2
    v_add_f32 v63, v66, v67
    v_smfmac_f32_16x16x64_bf16 v[84:87], v[44:47], a[96:103], v2
    ds_write_b128 v9, v[60:63] offset:0
    v_smfmac_f32_16x16x64_bf16 v[84:87], v[48:51], a[104:111], v2
    v_add_f32 v68, v68, v69
    v_smfmac_f32_16x16x64_bf16 v[88:91], v[44:47], a[112:119], v2
    v_add_f32 v69, v70, v71
    v_smfmac_f32_16x16x64_bf16 v[88:91], v[48:51], a[120:127], v2
    v_add_f32 v70, v72, v73
    v_add_f32 v71, v74, v75
    ds_write_b128 v9, v[68:71] offset:256
    v_add_f32 v76, v76, v77
    v_add_f32 v77, v78, v79
    v_add_f32 v78, v80, v81
    v_add_f32 v79, v82, v83
    ds_write_b128 v9, v[76:79] offset:512
    v_add_f32 v84, v84, v85
    v_add_f32 v85, v86, v87
    v_add_f32 v86, v88, v89
    v_add_f32 v87, v90, v91
    ds_write_b128 v9, v[84:87] offset:768
    s_waitcnt lgkmcnt(0)
    s_barrier
    ds_read_b128 v[44:47], v10 offset:0
    ds_read_b128 v[48:51], v10 offset:4096
    ds_read_b128 v[52:55], v10 offset:8192
    ds_read_b128 v[56:59], v10 offset:12288
    v_mov_b64 v[60:61], 0
    v_mov_b64 v[62:63], 0
    v_mov_b64 v[64:65], 0
    v_mov_b64 v[66:67], 0
    v_mov_b64 v[68:69], 0
    v_mov_b64 v[70:71], 0
    v_mov_b64 v[72:73], 0
    v_mov_b64 v[74:75], 0
    v_mov_b64 v[76:77], 0
    v_mov_b64 v[78:79], 0
    v_mov_b64 v[80:81], 0
    v_mov_b64 v[82:83], 0
    v_mov_b64 v[84:85], 0
    v_mov_b64 v[86:87], 0
    v_mov_b64 v[88:89], 0
    v_mov_b64 v[90:91], 0
    s_waitcnt lgkmcnt(2)
    v_pk_add_f32 v[44:45], v[44:45], v[48:49]
    v_pk_add_f32 v[46:47], v[46:47], v[50:51]
    s_waitcnt lgkmcnt(0)
    v_pk_add_f32 v[52:53], v[52:53], v[56:57]
    v_pk_add_f32 v[54:55], v[54:55], v[58:59]
    v_pk_add_f32 v[44:45], v[44:45], v[52:53]
    v_pk_add_f32 v[46:47], v[46:47], v[54:55]
    s_nop 0
    v_permlane32_swap_b32 v44, v45
    v_permlane32_swap_b32 v46, v47
    v_max_f32 v92, v44, v45
    v_max3_f32 v92, v92, v46, v47
    s_nop 1
    v_max_f32_dpp v92, v92, v92 row_ror:8
    s_nop 1
    v_max_f32_dpp v92, v92, v92 row_ror:4
    s_nop 1
    v_max_f32_dpp v92, v92, v92 row_ror:2
    s_nop 1
    v_max_f32_dpp v92, v92, v92 row_ror:1
    v_mov_b32 v94, v92
    s_nop 1
    v_permlane16_swap_b32 v94, v92
    v_max_f32 v92, v92, v94
    v_pk_add_f32 v[44:45], v[44:45], v[92:93] op_sel_hi:[1,0] neg_lo:[0,1] neg_hi:[0,1]
    v_pk_add_f32 v[46:47], v[46:47], v[92:93] op_sel_hi:[1,0] neg_lo:[0,1] neg_hi:[0,1]
    v_exp_f32 v44, v44
    v_exp_f32 v46, v46
    v_exp_f32 v45, v45
    v_exp_f32 v47, v47
    v_cvt_pk_bf16_f32 v48, v44, v46
    v_cvt_pk_bf16_f32 v49, v45, v47
    ds_write2_b32 v11, v48, v49 offset0:0 offset1:32
    v_pk_add_f32 v[44:45], v[44:45], v[46:47]
    v_add_f32 v93, v44, v45
    s_nop 1
    v_add_f32_dpp v93, v93, v93 row_ror:8
    s_nop 1
    v_add_f32_dpp v93, v93, v93 row_ror:4
    s_nop 1
    v_add_f32_dpp v93, v93, v93 row_ror:2
    s_waitcnt lgkmcnt(0)
    s_barrier
    ds_read_b128 v[44:47], v12 offset:0
    ds_read_b128 v[48:51], v12 offset:128
    v_add_f32_dpp v93, v93, v93 row_ror:1
    v_mov_b32 v94, v93
    s_nop 1
    v_permlane16_swap_b32 v94, v93
    v_add_f32 v93, v93, v94
    buffer_store_dwordx2 v[92:93], v13, s[32:35], s8 offen sc1
    s_add_u32 s81, s9, 65536
    s_waitcnt lgkmcnt(0)
    v_smfmac_f32_16x16x64_bf16 v[60:63], v[44:47], a[128:135], v2
Lpad_12:
    s_cbranch_execz Lresume_3
    v_smfmac_f32_16x16x64_bf16 v[60:63], v[48:51], a[136:143], v2
    v_smfmac_f32_16x16x64_bf16 v[64:67], v[44:47], a[144:151], v2
    v_smfmac_f32_16x16x64_bf16 v[64:67], v[48:51], a[152:159], v2
    v_smfmac_f32_16x16x64_bf16 v[68:71], v[44:47], a[160:167], v2
    v_smfmac_f32_16x16x64_bf16 v[68:71], v[48:51], a[168:175], v2
    v_smfmac_f32_16x16x64_bf16 v[72:75], v[44:47], a[176:183], v2
    v_smfmac_f32_16x16x64_bf16 v[72:75], v[48:51], a[184:191], v2
    s_nop 1
    v_add_f32 v60, v60, v61
    v_smfmac_f32_16x16x64_bf16 v[76:79], v[44:47], a[192:199], v2
    v_add_f32 v61, v62, v63
    v_smfmac_f32_16x16x64_bf16 v[76:79], v[48:51], a[200:207], v2
    v_add_f32 v64, v64, v65
    v_smfmac_f32_16x16x64_bf16 v[80:83], v[44:47], a[208:215], v2
    v_add_f32 v65, v66, v67
    v_smfmac_f32_16x16x64_bf16 v[80:83], v[48:51], a[216:223], v2
    v_cvt_pk_bf16_f32 v52, v60, v64
    v_cvt_pk_bf16_f32 v56, v61, v65
    v_smfmac_f32_16x16x64_bf16 v[84:87], v[44:47], a[224:231], v2
    v_add_f32 v68, v68, v69
    v_add_f32 v69, v70, v71
    v_smfmac_f32_16x16x64_bf16 v[84:87], v[48:51], a[232:239], v2
    v_add_f32 v72, v72, v73
    v_add_f32 v73, v74, v75
    v_smfmac_f32_16x16x64_bf16 v[88:91], v[44:47], a[240:247], v2
    v_cvt_pk_bf16_f32 v53, v68, v72
    v_cvt_pk_bf16_f32 v57, v69, v73
    v_smfmac_f32_16x16x64_bf16 v[88:91], v[48:51], a[248:255], v2
    buffer_store_dwordx2 v[52:53], v14, s[32:35], s9 offen offset:0 sc1
    buffer_store_dwordx2 v[56:57], v14, s[32:35], s81 offen offset:0 sc1
    v_add_f32 v76, v76, v77
    v_add_f32 v77, v78, v79
    v_add_f32 v80, v80, v81
    v_add_f32 v81, v82, v83
    v_cvt_pk_bf16_f32 v54, v76, v80
    v_cvt_pk_bf16_f32 v58, v77, v81
    v_add_f32 v84, v84, v85
    v_add_f32 v85, v86, v87
    v_add_f32 v88, v88, v89
    v_add_f32 v89, v90, v91
    v_cvt_pk_bf16_f32 v55, v84, v88
    v_cvt_pk_bf16_f32 v59, v85, v89
    buffer_store_dwordx2 v[54:55], v14, s[32:35], s9 offen offset:128 sc1
    buffer_store_dwordx2 v[58:59], v14, s[32:35], s81 offen offset:128 sc1
    buffer_load_dword v252, v15, s[32:35], s13 offen offset:0 sc1
    s_waitcnt vmcnt(1)
    s_barrier
    buffer_load_dwordx2 v[52:53], v17, s[32:35], s11 offen sc1
    buffer_load_dwordx4 v[44:47], v15, s[32:35], s10 offen sc1
    buffer_load_dwordx4 v[48:51], v15, s[32:35], s10 offen offset:1024 sc1
    s_branch Lbody_40
Lagain_39:
    s_mov_b64 exec, vcc
    buffer_load_dwordx2 v[52:53], v17, s[32:35], s11 offen sc1
    buffer_load_dwordx4 v[44:47], v15, s[32:35], s10 offen sc1
    buffer_load_dwordx4 v[48:51], v15, s[32:35], s10 offen offset:1024 sc1
    s_mov_b64 exec, -1
    s_add_u32 s85, s85, 1
    s_cmp_gt_u32 s85, 1048576
    s_cselect_b32 s89, -1, -2
Lbody_40:
    s_waitcnt vmcnt(2)
    v_max_f32_dpp v57, v52, v52 row_ror:8
    v_max_u32 v56, v52, v53
    s_nop 0
    v_max_f32_dpp v57, v57, v57 row_ror:4
    s_nop 1
    v_max_f32_dpp v57, v57, v57 row_ror:2
    s_nop 1
    v_max_f32_dpp v57, v57, v57 row_ror:1
    v_mov_b32 v58, v57
    s_nop 1
    v_permlane16_swap_b32 v58, v57
    v_max_f32 v57, v57, v58
    v_sub_f32 v54, v52, v57
    v_exp_f32 v54, v54
    s_nop 0
    v_cvt_pk_bf16_f32 v54, v54, v54
    v_and_b32 v59, 0xffff0000, v54
    v_mul_f32 v59, v59, v53
    v_and_b32_dpp v60, v54, v40 row_newbcast:0
    v_and_b32_dpp v61, v54, v41 row_newbcast:0
    v_and_b32_dpp v62, v54, v42 row_newbcast:0
    v_and_b32_dpp v63, v54, v43 row_newbcast:0
    v_and_b32_dpp v64, v54, v40 row_newbcast:2
    v_and_b32_dpp v65, v54, v41 row_newbcast:2
    v_and_b32_dpp v66, v54, v42 row_newbcast:2
    v_and_b32_dpp v67, v54, v43 row_newbcast:2
    s_waitcnt vmcnt(1)
    v_mfma_f32_16x16x32_bf16 v[68:71], v[60:63], v[44:47], 0
    s_waitcnt vmcnt(0)
    v_mfma_f32_16x16x32_bf16 v[68:71], v[64:67], v[48:51], v[68:71]
    v_max3_u32 v56, v56, v44, v45
    v_max3_u32 v56, v56, v46, v47
    v_max3_u32 v56, v56, v48, v49
    v_max3_u32 v56, v56, v50, v51
    v_cmp_lt_u32 vcc, s89, v56
    s_cbranch_vccnz Lagain_39
Lok_38:
    s_nop 1
    v_cvt_pk_bf16_f32 v68, v68, v69
    v_cvt_pk_bf16_f32 v69, v70, v71
    ds_write_b64 v18, v[68:69]
    s_waitcnt lgkmcnt(0)
    s_barrier
    ds_read_b128 v[60:63], v19 offset:0
    ds_read_b128 v[64:67], v19 offset:64
    ds_read_b128 v[68:71], v19 offset:128
    ds_read_b128 v[72:75], v19 offset:192
    v_add_f32_dpp v59, v59, v59 row_ror:8
    s_nop 1
    v_add_f32_dpp v59, v59, v59 row_ror:4
    s_nop 1
    v_add_f32_dpp v59, v59, v59 row_ror:2
    s_nop 1
    v_add_f32_dpp v59, v59, v59 row_ror:1
    s_waitcnt lgkmcnt(3)
    v_mfma_f32_16x16x32_bf16 v[76:79], v[60:63], v[128:131], 0
    v_mfma_f32_16x16x32_bf16 v[80:83], v[60:63], v[132:135], 0
    s_waitcnt lgkmcnt(2)
    v_mfma_f32_16x16x32_bf16 v[76:79], v[64:67], v[136:139], v[76:79]
    v_mfma_f32_16x16x32_bf16 v[80:83], v[64:67], v[140:143], v[80:83]
    s_waitcnt lgkmcnt(1)
    v_mfma_f32_16x16x32_bf16 v[76:79], v[68:71], v[144:147], v[76:79]
    v_mfma_f32_16x16x32_bf16 v[80:83], v[68:71], v[148:151], v[80:83]
    s_waitcnt lgkmcnt(0)
    v_mfma_f32_16x16x32_bf16 v[76:79], v[72:75], v[152:155], v[76:79]
    v_mfma_f32_16x16x32_bf16 v[80:83], v[72:75], v[156:159], v[80:83]
    v_mov_b32 v57, v59
    s_nop 1
    v_permlane16_swap_b32 v57, v59
    v_add_f32 v59, v59, v57
    v_rcp_f32 v59, v59
    s_cmp_eq_u32 s84, 0
    v_pk_add_f32 v[76:77], v[76:77], v[78:79]
    v_pk_add_f32 v[80:81], v[80:81], v[82:83]
    v_add_f32 v76, v76, v77
    v_add_f32 v80, v80, v81
    v_mul_f32 v76, v76, v59
    v_mul_f32 v80, v80, v59
    v_cvt_pk_bf16_f32 v76, v76, v80
    s_cbranch_scc1 Lslow_41
    buffer_store_dword v76, v20, s[32:35], s12 offen
Lback_42:
    s_waitcnt vmcnt(0)
    buffer_load_dwordx4 v[44:47], v21, s[32:35], s13 offen sc1
    s_branch Lbody_45
Lagain_44:
    s_mov_b64 exec, vcc
    buffer_load_dwordx4 v[44:47], v21, s[32:35], s13 offen sc1
    s_mov_b64 exec, -1
    s_add_u32 s85, s85, 1
    s_cmp_gt_u32 s85, 1048576
    s_cselect_b32 s89, -1, -2
Lbody_45:
    s_waitcnt vmcnt(0)
    v_mfma_f32_16x16x32_bf16 v[60:63], v[44:47], v[192:195], 0
    v_mov_b32_dpp v48, v44 row_shl:4
    v_mov_b32_dpp v49, v45 row_shl:4
    v_mfma_f32_16x16x32_bf16 v[64:67], v[44:47], v[196:199], 0
    v_mov_b32_dpp v50, v46 row_shl:4
    v_mov_b32_dpp v51, v47 row_shl:4
    s_nop 1
    v_mfma_f32_16x16x32_bf16 v[60:63], v[48:51], v[200:203], v[60:63]
    v_mov_b32_dpp v52, v44 row_shl:8
    v_mov_b32_dpp v53, v45 row_shl:8
    v_mfma_f32_16x16x32_bf16 v[64:67], v[48:51], v[204:207], v[64:67]
    v_mov_b32_dpp v54, v46 row_shl:8
    v_mov_b32_dpp v55, v47 row_shl:8
    s_nop 1
    v_mfma_f32_16x16x32_bf16 v[60:63], v[52:55], v[208:211], v[60:63]
    v_mov_b32_dpp v56, v44 row_shl:12
    v_mov_b32_dpp v57, v45 row_shl:12
    v_mfma_f32_16x16x32_bf16 v[64:67], v[52:55], v[212:215], v[64:67]
    v_mov_b32_dpp v58, v46 row_shl:12
    v_mov_b32_dpp v59, v47 row_shl:12
    s_nop 1
    v_mfma_f32_16x16x32_bf16 v[60:63], v[56:59], v[216:219], v[60:63]
Lpad_13:
    s_cbranch_execz Lresume_3
    v_mfma_f32_16x16x32_bf16 v[64:67], v[56:59], v[220:223], v[64:67]
    v_max3_u32 v68, v44, v45, v46
    v_max_u32 v68, v68, v47
    v_cmp_lt_u32 vcc, s89, v68
    s_cbranch_vccnz Lagain_44
Lok_43:
    s_nop 2
    v_pk_add_f32 v[60:61], v[60:61], v[62:63]
    v_pk_add_f32 v[64:65], v[64:65], v[66:67]
    v_add_f32 v60, v60, v61
    v_add_f32 v64, v64, v65
    ds_write2_b32 v36, v60, v64 offset0:0 offset1:64
    s_waitcnt lgkmcnt(0)
    s_barrier
    ds_read_b128 v[44:47], v37
    s_waitcnt lgkmcnt(0)
    v_pk_add_f32 v[44:45], v[44:45], v[46:47]
    v_add_f32 v44, v44, v45
    s_nop 1
    v_mov_b32_dpp v45, v44 quad_perm:[1,1,3,3]
    v_cvt_pk_bf16_f32 v44, v44, v45
    buffer_store_dword v44, v35, s[32:35], s14 offen sc1
    buffer_load_dword v87, v26, s[32:35], s17 offen offset:0 sc1
    buffer_load_dword v87, v16, s[32:35], s17 offen offset:0 sc1
    ds_read_b64 v[72:73], v34
    v_and_b32 v68, s88, v40
    v_and_b32 v69, s88, v41
    v_and_b32 v70, s88, v42
    v_and_b32 v71, s88, v43
    s_waitcnt lgkmcnt(0)
    v_and_b32 v75, 0xffff0000, v73
    v_lshlrev_b32 v74, 16, v73
    v_and_b32 v73, 0xffff0000, v72
    v_lshlrev_b32 v72, 16, v72
    s_waitcnt vmcnt(2)
    s_barrier
    buffer_load_dwordx4 v[44:47], v25, s[32:35], s15 offen offset:0 sc1
    buffer_load_dwordx4 v[48:51], v25, s[32:35], s15 offen offset:1024 sc1
    s_mov_b32 s23, 0x00003f80
    s_mov_b32 s24, 0x3f800000
    v_mov_b32 v85, 133152
    v_mov_b64 v[76:77], 0
    v_mov_b64 v[78:79], 0
    v_mov_b64 v[80:81], 0
    v_mov_b64 v[82:83], 0
    s_branch Lbody_48
Lagain_47:
    s_mov_b64 exec, vcc
    buffer_load_dwordx4 v[44:47], v25, s[32:35], s15 offen offset:0 sc1
    buffer_load_dwordx4 v[48:51], v25, s[32:35], s15 offen offset:1024 sc1
    s_mov_b64 exec, -1
    s_add_u32 s85, s85, 1
    s_cmp_gt_u32 s85, 1048576
    s_cselect_b32 s89, -1, -2
Lbody_48:
    s_waitcnt vmcnt(1)
    v_mfma_f32_16x16x32_bf16 v[52:55], v[68:71], v[44:47], v[72:75]
    s_waitcnt vmcnt(0)
    v_mfma_f32_16x16x32_bf16 v[52:55], v[68:71], v[48:51], v[52:55]
    v_max3_u32 v60, v44, v45, v46
    v_max3_u32 v60, v60, v47, v48
    v_max3_u32 v60, v60, v49, v50
    v_max_u32 v60, v60, v51
    v_cmp_lt_u32 vcc, s89, v60
    s_cbranch_vccnz Lagain_47
Lok_46:
    s_nop 1
    v_cvt_pk_bf16_f32 v52, v52, v53
    v_cvt_pk_bf16_f32 v53, v54, v55
    ds_write_b64 v34, v[52:53]
    v_dot2_f32_bf16 v88, v52, s88, 0
    v_dot2_f32_bf16 v89, v52, v52, 0
    v_dot2_f32_bf16 v88, v53, s88, v88
    v_dot2_f32_bf16 v89, v53, v53, v89
    s_nop 1
    v_add_f32_dpp v88, v88, v88 row_ror:8
    v_add_f32_dpp v89, v89, v89 row_ror:8
    s_nop 0
    v_add_f32_dpp v88, v88, v88 row_ror:4
    v_add_f32_dpp v89, v89, v89 row_ror:4
    s_nop 0
    v_add_f32_dpp v88, v88, v88 row_ror:2
    v_add_f32_dpp v89, v89, v89 row_ror:2
    s_nop 0
    v_add_f32_dpp v88, v88, v88 row_ror:1
    v_add_f32_dpp v89, v89, v89 row_ror:1
    s_nop 0
    v_add_f32_dpp v88, v88, v88 row_bcast:15 row_mask:0xa
    v_add_f32_dpp v89, v89, v89 row_bcast:15 row_mask:0xa
    ds_write_b64 v39, v[88:89] offset:32
    s_waitcnt lgkmcnt(0)
    s_barrier
    ds_read_b128 v[44:47], v33 offset:0
    ds_read_b128 v[48:51], v33 offset:128
    ds_read_b128 v[60:63], v85
    ds_read_b128 v[64:67], v85 offset:16
    s_mov_b32 s81, 0x3b000000
    v_lshlrev_b32 v86, 2, v20
    v_max_u32 v86, v86, v20
    s_waitcnt lgkmcnt(3)
    v_smfmac_f32_16x16x64_bf16 v[76:79], v[44:47], v[160:167], v2
    v_smfmac_f32_16x16x64_bf16 v[80:83], v[44:47], v[176:183], v2
    s_waitcnt lgkmcnt(2)
    v_smfmac_f32_16x16x64_bf16 v[76:79], v[48:51], v[168:175], v2
    v_smfmac_f32_16x16x64_bf16 v[80:83], v[48:51], v[184:191], v2
    s_waitcnt lgkmcnt(0)
    v_add_f32 v60, v60, v64
    v_add_f32 v61, v61, v65
    v_add_f32 v62, v62, v66
    v_add_f32 v63, v63, v67
    v_add_f32 v60, v60, v62
    v_add_f32 v61, v61, v63
    v_mul_f32 v60, s81, v60
    v_mul_f32 v62, v60, v60
    v_fma_f32 v62, v61, s81, -v62
    v_max_f32 v62, 0, v62
    v_add_f32 v62, 0x3727c5ac, v62
    v_rsq_f32 v61, v62
    s_cmp_eq_u32 s84, 0
    v_add_f32 v76, v76, v77
    v_add_f32 v80, v80, v81
    v_fma_f32 v76, -v60, v29, v76
    v_fma_f32 v80, -v60, v30, v80
    v_mul_f32 v76, v61, v76
    v_mul_f32 v80, v61, v80
    v_cvt_pk_bf16_f32 v76, v76, v80
    s_cbranch_scc1 Lslow_49
    buffer_store_dword v76, v86, s[32:35], s16 offen
Lback_50:
    v_and_b32 v84, 15, v1
    s_add_u32 s82, s20, 131072
    v_lshl_add_u32 v84, v84, 1, s82
    ds_read_u16 v84, v84
    s_cmp_eq_u32 s80, 0
    s_cselect_b32 s82, 0x10000, 0
    v_mov_b32 v88, 0xc0135761
    v_mov_b32 v89, 0xc0135761
    v_add_u32 v95, 1280, v22
    v_and_b32 v93, 0x11, v1
    v_cmp_eq_u32 vcc, 0, v93
    v_lshrrev_b32 v93, 5, v1
    v_mul_u32_u24 v93, 8128, v93
    v_lshl_add_u32 v93, v1, 1, v93
    v_mov_b32 v94, 1073741824
    v_cndmask_b32 v94, v94, v93, vcc
    s_waitcnt vmcnt(0)
    buffer_load_dwordx4 v[52:55], v26, s[32:35], s17 offen sc1
    buffer_load_dwordx4 v[56:59], v16, s[32:35], s17 offen sc1
    s_branch Lbody_53
Lagain_52:
    s_mov_b64 exec, vcc
    buffer_load_dwordx4 v[52:55], v26, s[32:35], s17 offen sc1
    buffer_load_dwordx4 v[56:59], v16, s[32:35], s17 offen sc1
    s_mov_b64 exec, -1
    s_add_u32 s85, s85, 1
    s_cmp_gt_u32 s85, 1048576
    s_cselect_b32 s89, -1, -2
Lbody_53:
    s_waitcnt vmcnt(0)
    v_dot2_f32_bf16 v60, v52, s23, 0
    v_dot2_f32_bf16 v61, v56, s23, 0
    v_dot2_f32_bf16 v62, v52, s24, 0
    v_dot2_f32_bf16 v63, v56, s24, 0
    v_dot2_f32_bf16 v60, v53, s23, v60
    v_dot2_f32_bf16 v61, v57, s23, v61
    v_dot2_f32_bf16 v62, v53, s24, v62
    v_dot2_f32_bf16 v63, v57, s24, v63
    v_dot2_f32_bf16 v60, v54, s23, v60
    v_dot2_f32_bf16 v61, v58, s23, v61
    v_dot2_f32_bf16 v62, v54, s24, v62
    v_dot2_f32_bf16 v63, v58, s24, v63
    v_dot2_f32_bf16 v60, v55, s23, v60
    v_dot2_f32_bf16 v61, v59, s23, v61
    v_dot2_f32_bf16 v62, v55, s24, v62
    v_dot2_f32_bf16 v63, v59, s24, v63
    v_max3_u32 v64, v52, v53, v54
    v_max3_u32 v64, v64, v55, v56
    v_max3_u32 v64, v64, v57, v58
    v_max_u32 v64, v64, v59
    v_cmp_lt_u32 vcc, s89, v64
    s_cbranch_vccnz Lagain_52
Lok_51:
    v_mul_f32 v90, v60, v60
    v_mul_f32 v91, v61, v61
    v_fmac_f32 v88, 0xbdd2d3e8, v90
Lpad_14:
    s_cbranch_execz Lresume_3
    v_fmac_f32 v89, 0xbdd2d3e8, v91
    v_mul_f32 v88, v88, v60
    v_mul_f32 v89, v89, v61
    v_exp_f32 v88, v88
    v_exp_f32 v89, v89
    v_mul_f32 v60, v60, v62
    v_mul_f32 v61, v61, v63
    v_add_f32 v88, 1.0, v88
    v_add_f32 v89, 1.0, v89
    v_rcp_f32 v88, v88
    v_rcp_f32 v89, v89
    v_mul_f32 v60, v60, v88
    v_mul_f32 v61, v61, v89
    v_cvt_pk_bf16_f32 v60, v60, v61
    s_nop 1
    v_mov_b32_dpp v44, v60 quad_perm:[0,0,0,0]
    v_mov_b32_dpp v45, v60 quad_perm:[1,1,1,1]
    v_mov_b32_dpp v46, v60 quad_perm:[2,2,2,2]
    v_mov_b32_dpp v47, v60 quad_perm:[3,3,3,3]
    s_nop 1
    v_mfma_f32_16x16x32_bf16 v[68:71], v[44:47], v[224:227], 0
    v_mfma_f32_16x16x32_bf16 v[72:75], v[44:47], v[228:231], 0
    v_mfma_f32_16x16x32_bf16 v[76:79], v[44:47], v[232:235], 0
    v_mfma_f32_16x16x32_bf16 v[80:83], v[44:47], v[236:239], 0
    s_nop 5
    ds_write2_b32 v95, v68, v72 offset0:0 offset1:20
    s_nop 0
    ds_write2_b32 v95, v76, v80 offset0:40 offset1:60
    s_waitcnt lgkmcnt(0)
    s_barrier
    ds_read_b128 v[44:47], v23 offset:1280
    v_mul_u32_u24 v84, s82, v84
    s_waitcnt lgkmcnt(0)
    v_pk_add_f32 v[44:45], v[44:45], v[46:47]
    v_add_f32 v44, v44, v45
    v_mov_b32 v45, v44
    s_nop 1
    v_permlane16_swap_b32 v45, v44
    v_add_f32 v44, v44, v45
    v_mov_b32 v45, v44
    s_nop 1
    v_permlane32_swap_b32 v45, v44
    v_add_f32 v44, v44, v45
    v_add_f32 v84, v84, v44
    s_nop 1
    v_mov_b32_dpp v45, v84 quad_perm:[1,1,3,3]
    v_cvt_pk_bf16_f32 v44, v84, v45
    buffer_store_dword v44, v24, s[32:35], s18 offen sc1
    s_or_b32 s81, s80, s76
    s_cmp_lg_u32 s81, 0
    s_cbranch_scc1 Lfin
    v_lshrrev_b32 v45, 4, v1
    v_and_b32 v46, 15, v1
    v_lshlrev_b32 v45, 10, v45
    v_cmp_gt_u32 vcc, 16, v1
    v_lshl_add_u32 v45, v46, 1, v45
    v_mov_b32 v46, 1073741824
    v_cndmask_b32 v45, v45, v46, vcc
    s_waitcnt vmcnt(0)
    buffer_load_ushort v44, v45, s[32:35], s18 offen sc1
    s_cmp_gt_u32 s85, 1048576
    s_branch Lbody_56
Lagain_55:
    s_mov_b64 exec, vcc
    buffer_load_ushort v44, v45, s[32:35], s18 offen sc1
    s_mov_b64 exec, -1
    s_add_u32 s85, s85, 1
    s_cmp_gt_u32 s85, 1048576
Lbody_56:
    s_waitcnt vmcnt(0)
    v_cmp_eq_u32 vcc, 0xffff, v44
    v_lshlrev_b32 v46, 16, v44
    s_cbranch_scc1 Lok_54
    s_cbranch_vccnz Lagain_55
Lok_54:
    v_mov_b32 v47, v46
    s_nop 1
    v_permlane16_swap_b32 v47, v46
    v_add_f32 v46, v46, v47
    v_mov_b32 v47, v46
    s_nop 1
    v_permlane32_swap_b32 v47, v46
    v_add_f32 v46, v46, v47
    v_add_f32 v44, v84, v46
    s_nop 1
    v_mov_b32_dpp v45, v44 quad_perm:[1,1,3,3]
    v_cvt_pk_bf16_f32 v44, v44, v45
    buffer_store_dword v44, v24, s[72:75], s20 offen
Lfin:
Lend:
    s_endpgm
Lslow_14:
    buffer_store_dword v76, v20, s[32:35], s12 offen sc1
    s_branch Lback_15
Lslow_22:
    buffer_store_dword v76, v86, s[32:35], s16 offen sc1
    s_branch Lback_23
Lslow_30:
    buffer_store_dword v52, v5, s[32:35], s4 offen sc1
    s_branch Lback_31
Lslow_41:
    buffer_store_dword v76, v20, s[32:35], s12 offen sc1
    s_branch Lback_42
Lslow_49:
    buffer_store_dword v76, v86, s[32:35], s16 offen sc1
    s_branch Lback_50
.section .rodata,"a"
.p2align 6
.amdhsa_kernel interleave_layers__compressed_kv_cla__glu_gated_geglu__decode_kernel
  .amdhsa_next_free_vgpr 512
  .amdhsa_next_free_sgpr 102
  .amdhsa_accum_offset 256
  .amdhsa_group_segment_fixed_size 0
  .amdhsa_kernarg_size 104
  .amdhsa_user_sgpr_count 2
  .amdhsa_user_sgpr_kernarg_segment_ptr 1
  .amdhsa_system_sgpr_workgroup_id_x 1
.end_amdhsa_kernel
```
